```python
import torch

def _softmax(x, axis=-1):
    return torch.softmax(x, dim=axis)

def _gelu(x):
    return torch.nn.functional.gelu(x, approximate='tanh')

def _silu(x):
    return torch.nn.functional.silu(x)

def _sigmoid(x):
    return torch.sigmoid(x)

def _layernorm(x, axis=-1, eps=1e-05):
    m = x.mean(dim=axis, keepdim=True)
    v = x.var(dim=axis, keepdim=True, unbiased=False)
    return (x - m) / torch.sqrt(v + eps)

def _scatter_add(tgt, idx, src, axis=0):
    return tgt.clone().index_add_(axis, idx, src)

def _segment_sum(src, seg, n):
    out = torch.zeros((n,) + src.shape[1:], dtype=src.dtype)
    return out.index_add_(0, seg, src)

def _pad(x, pw):
    flat = tuple((v for pair in reversed(pw) for v in pair))
    return torch.nn.functional.pad(x, flat)
kernel_name = 'standalone__ragged_sequences_varlen_flash_attn__ragged'

def setup_inputs():

    _w = lambda a: (lambda t: t.to(torch.bfloat16) if t.is_floating_point() else t)(torch.as_tensor(a))
    cu = torch.tensor([0, 506, 648, 1109, 1416, 1494, 1644, 1941, 2399], dtype=torch.int64)
    T = int(cu[-1])
    Hq, Hkv, D = (16, 8, 192)
    assert Hq % Hkv == 0
    return {'q': _w((lambda *s: torch.randn(*s, dtype=torch.bfloat16) * 0.8)(T, Hq, D)), 'k': _w((lambda *s: torch.randn(*s, dtype=torch.bfloat16) * 0.8)(T, Hkv, D)), 'v': _w((lambda *s: torch.randn(*s, dtype=torch.bfloat16) * 0.05)(T, Hkv, D)), 'cu': _w(cu)}

def reference(q, k, v, cu):
    T, Hq, D = q.shape
    Hkv = k.shape[1]
    rep = Hq // Hkv
    scale = D ** (-0.5)
    outs = []
    for i in range(len(cu) - 1):
        s, e = (int(cu[i]), int(cu[i + 1]))
        L = e - s
        qi = q[s:e].clone()
        ki = (lambda x, n, axis: torch.repeat_interleave(x, n, dim=axis))(k[s:e], rep, axis=1)
        vi = (lambda x, n, axis: torch.repeat_interleave(x, n, dim=axis))(v[s:e], rep, axis=1)
        logits = torch.einsum('qhd,khd->hqk', qi, ki) * scale
        ar = torch.arange(L)
        neg = (lambda x, dt: x.to(dt))(ar[None, :] > ar[:, None], logits.dtype) * -1000000000.0
        p = _softmax(logits + neg[None, :, :], axis=-1)
        outs.append(torch.einsum('hqk,khd->qhd', p, vi))
    return torch.concatenate(outs, axis=0)
```

```asm
; @launch grid=(256,1,1) block=(256,1,1) lds=163840
.amdgcn_target "amdgcn-amd-amdhsa--gfx950"
.text
.globl standalone__ragged_sequences_varlen_flash_attn__ragged_kernel
.p2align 12
.p2align 8
.type standalone__ragged_sequences_varlen_flash_attn__ragged_kernel,@function
standalone__ragged_sequences_varlen_flash_attn__ragged_kernel:
    s_cmp_ge_u32 s2, 256
    s_cbranch_scc1 L_end
    s_load_dwordx2 s[8:9], s[0:1], 8
    s_load_dwordx2 s[4:5], s[0:1], 0
    s_load_dwordx2 s[12:13], s[0:1], 16
    s_load_dwordx2 s[16:17], s[0:1], 32
    s_getpc_b64 s[96:97]
L_pc:
    s_lshr_b32 m0, s2, 5
    s_mov_b32 s48, 0x303f3a38
    s_mov_b32 s49, 0x2a283732
    s_mov_b32 s50, 0x1210092f
    s_mov_b32 s51, 0xe6e3e2e0
    s_mov_b32 s52, 0x1511cae7
    s_mov_b32 s53, 0xf0e0d0b
    s_mov_b32 s54, 0xdedbdad8
    s_mov_b32 s55, 0xd7d6d3df
    s_and_b32 s90, s2, 0x18
    s_movrels_b32 s89, s48
    s_andn2_b32 s88, s2, 7
    s_lshr_b32 s89, s89, s90
    s_lshl2_add_u32 s95, s88, L_duty-L_pc
    s_bitcmp1_b32 s89, 6
    s_cselect_b32 s95, s95, 0
    s_load_dwordx8 s[40:47], s[96:97], s95
    v_lshrrev_b32 v168, 6, v0
    v_and_b32 v246, 63, v0
    v_readfirstlane_b32 s20, v168
    v_lshrrev_b32 v170, 5, v0
    v_add_lshl_u32 v170, v170, s88, 7
    v_min_u32 v170, L_cold-L_pc, v170
    global_load_dword v251, v170, s[96:97]
    s_mov_b32 s56, 0x881fa000
    s_mov_b32 s57, 0x5884552
    s_mov_b32 s58, 0x6c5d6588
    s_mov_b32 s59, 0x95f7956
    s_bitcmp1_b32 s89, 2
    s_cselect_b64 s[56:57], s[58:59], s[56:57]
    s_and_b32 s91, s89, 3
    s_mul_i32 s91, s91, 12
    s_lshr_b64 s[56:57], s[56:57], s91
    s_and_b32 s91, s56, 0xfff
    s_bfe_u32 s92, s56, 0xc000c
    s_mul_i32 s49, s92, 6144
    s_and_b32 s95, s2, 7
    s_mul_i32 s95, s95, 384
    s_mul_i32 s91, s91, 3072
    s_add_u32 s22, s91, s95
    s_bfe_u32 s92, s89, 0x30003
    s_mul_i32 s92, s92, 393216
    s_lshl1_add_u32 s80, s22, s92
    s_mul_i32 s93, s20, 24576
    s_lshr_b32 s21, s20, 1
    s_mul_i32 s24, s20, 3072
    s_and_b32 s90, s20, 1
    s_lshl_b32 s91, s90, 6
    v_mov_b32 v0, s93
    s_movk_i32 s92, 3072
    v_mul_u32_u24 v160, 2731, v246
    v_lshrrev_b32 v169, 16, v160
    v_lshrrev_b32 v171, 17, v160
    v_xor_b32 v171, v246, v171
    v_mul_u32_u24 v164, 2688, v169
    v_lshl_add_u32 v174, v171, 4, v164
    v_mad_u32_u24 v224, v169, s92, v174
    v_xad_u32 v7, v174, s91, v0
    v_xor_b32 v227, 64, v224
    v_add_u32 v161, 174784, v160
    v_lshrrev_b32 v169, 16, v161
    v_lshrrev_b32 v171, 17, v161
    v_xor_b32 v171, v246, v171
    v_mul_u32_u24 v165, 2688, v169
    v_lshl_add_u32 v174, v171, 4, v165
    v_mad_u32_u24 v225, v169, s92, v174
    v_xad_u32 v8, v174, s91, v0
    v_xor_b32 v228, 64, v225
    v_add_u32 v162, 349568, v160
    v_lshrrev_b32 v169, 16, v162
    v_lshrrev_b32 v171, 17, v162
    v_xor_b32 v171, v246, v171
    v_mul_u32_u24 v166, 2688, v169
    v_lshl_add_u32 v174, v171, 4, v166
    v_mad_u32_u24 v226, v169, s92, v174
    v_xad_u32 v9, v174, s91, v0
    v_xor_b32 v229, 64, v226
    s_mul_i32 s90, s90, 384
    s_mul_i32 s29, s21, 196608
    s_add_u32 s29, s29, s90
    s_mul_i32 s28, s20, 12288
    s_add_u32 s28, s28, 114688
    s_mov_b32 s11, 0x20000
    s_mov_b32 s7, s11
    s_mov_b32 s15, s11
    s_mov_b32 s19, s11
    s_mov_b32 s10, 7369728
    s_add_u32 s80, s80, s29
    s_lshr_b32 s91, s2, 3
    s_lshl1_add_u32 s92, s91, s21
    s_mul_i32 s92, s92, 6144
    s_lshl1_add_u32 s94, s95, s90
    s_add_u32 s92, s92, s94
    s_add_u32 s50, s92, 2752512
    s_mul_i32 s91, s91, 3072
    s_lshl_b32 s92, s90, 8
    s_add_u32 s91, s91, s92
    s_add_u32 s91, s91, s95
    s_cmp_eq_u32 s21, 0
    s_cselect_b32 s51, s91, 2146435072
    s_cselect_b32 s52, 2146435072, s91
    v_lshlrev_b32 v172, 7, v246
    s_mov_b32 s6, 14739456
    s_mov_b32 s14, 7369728
    s_bitcmp0_b32 s89, 6
    s_cbranch_scc1 L_own0
    v_mul_u32_u24 v168, 21846, v246
    v_lshrrev_b32 v168, 16, v168
    v_mul_u32_u24 v169, 3, v168
    v_sub_u32 v169, v246, v169
    v_mul_u32_u24 v168, 3072, v168
    v_lshl_add_u32 v240, v169, 7, v168
    v_add_u32 v247, v240, v168
    s_lshl1_add_u32 s88, s95, s29
    s_add_u32 s95, s95, s93
    v_add_u32 v171, s88, v247
    v_add_u32 v170, s95, v240
    s_waitcnt lgkmcnt(0)
    s_mov_b64 exec, 7
    buffer_load_dword v251, v172, s[4:7], s50 offen
    buffer_load_dword v251, v172, s[8:11], s51 offen
    buffer_load_dword v251, v172, s[12:15], s52 offen
    s_mov_b64 exec, -1
    s_mov_b32 exec_hi, 0xffff
    buffer_load_dword v251, v171, s[4:7], s40 offen
    s_mov_b64 exec, 0xffffff
    buffer_load_dword v251, v170, s[8:11], s41 offen
    buffer_load_dword v251, v170, s[12:15], s42 offen
    buffer_load_dword v251, v170, s[8:11], s43 offen
    s_bitcmp0_b32 s89, 7
    s_mov_b64 exec, -1
    s_cbranch_scc1 L_own
    s_mov_b32 exec_hi, 0xffff
    buffer_load_dword v251, v171, s[4:7], s44 offen
    s_mov_b64 exec, 0xffffff
    buffer_load_dword v251, v170, s[12:15], s45 offen
    buffer_load_dword v251, v170, s[8:11], s46 offen
    buffer_load_dword v251, v170, s[12:15], s47 offen
    s_mov_b64 exec, -1
    s_branch L_own
L_own0:
    s_waitcnt lgkmcnt(0)
    s_mov_b64 exec, 7
    buffer_load_dword v251, v172, s[4:7], s50 offen
    buffer_load_dword v251, v172, s[8:11], s51 offen
    buffer_load_dword v251, v172, s[12:15], s52 offen
    s_mov_b64 exec, -1
L_own:
    s_mov_b32 s6, s49
    s_add_u32 m0, s24, 0
    s_nop 0
    buffer_load_dwordx4 v7, s[8:11], s22 offen offset:0 lds
    buffer_load_dwordx4 v8, s[8:11], s22 offen offset:1024 lds
    buffer_load_dwordx4 v9, s[8:11], s22 offen offset:2048 lds
    s_add_u32 m0, s28, 0
    s_add_u32 s23, s22, 98304
    buffer_load_dwordx4 v224, s[4:7], s80 offen offset:0 nt lds
    buffer_load_dwordx4 v225, s[4:7], s80 offen offset:1024 nt lds
    buffer_load_dwordx4 v226, s[4:7], s80 offen offset:2048 nt lds
    s_add_u32 m0, s28, 3072
    s_add_u32 s80, s80, 49152
    buffer_load_dwordx4 v227, s[4:7], s80 offen offset:0 nt lds
    buffer_load_dwordx4 v228, s[4:7], s80 offen offset:1024 nt lds
    buffer_load_dwordx4 v229, s[4:7], s80 offen offset:2048 nt lds
    s_lshl_b32 s94, s2, 5
    s_add_u32 s94, s94, L_table-L_pc
    s_load_dwordx8 s[32:39], s[96:97], s94
    s_lshl_b32 s30, s2, 7
    s_add_u32 s30, s30, L_steps+16-L_pc
    s_load_dword s44, s[96:97], s30
    s_load_dword s45, s[96:97], s30 offset:64
    s_add_u32 m0, s28, 6144
    s_add_u32 s80, s80, 49152
    buffer_load_dwordx4 v224, s[4:7], s80 offen offset:0 nt lds
    buffer_load_dwordx4 v225, s[4:7], s80 offen offset:1024 nt lds
    buffer_load_dwordx4 v226, s[4:7], s80 offen offset:2048 nt lds
    v_lshl_add_u32 v168, v246, 4, v164
    v_bfe_u32 v169, v160, 17, 1
    v_lshlrev_b32 v169, 6, v169
    v_xad_u32 v10, v168, v169, v0
    v_lshl_add_u32 v168, v246, 4, v165
    v_bfe_u32 v169, v161, 17, 1
    v_lshlrev_b32 v169, 6, v169
    v_xad_u32 v11, v168, v169, v0
    v_lshl_add_u32 v168, v246, 4, v166
    v_bfe_u32 v169, v162, 17, 1
    v_lshlrev_b32 v169, 6, v169
    v_xad_u32 v12, v168, v169, v0
    v_and_b32 v168, 31, v246
    v_lshrrev_b32 v169, 5, v246
    v_bfe_u32 v170, v246, 1, 3
    v_mul_u32_u24 v171, 384, v168
    v_xor_b32 v172, v169, v170
    v_lshl_add_u32 v1, v172, 4, v171
    v_xor_b32 v2, 32, v1
    v_xor_b32 v3, 64, v1
    v_xor_b32 v4, 96, v1
    v_add_u32 v242, s28, v1
    v_add_u32 v243, s28, v2
    v_add_u32 v244, s28, v3
    v_add_u32 v245, s28, v4
    v_bfe_u32 v170, v246, 2, 2
    v_lshl_add_u32 v171, v169, 2, v170
    v_mul_u32_u24 v171, 384, v171
    v_bfe_u32 v172, v246, 4, 1
    v_lshl_add_u32 v171, v172, 4, v171
    v_and_b32 v172, 1, v246
    v_lshl_add_u32 v171, v172, 5, v171
    v_bfe_u32 v172, v246, 1, 1
    v_lshl_add_u32 v171, v172, 3, v171
    v_bfe_u32 v172, v246, 3, 1
    v_lshlrev_b32 v172, 6, v172
    v_add_u32 v5, v171, v172
    v_sub_u32 v6, v171, v172
    v_add_u32 v5, 65536, v5
    v_add_u32 v6, 65536, v6
    s_mov_b32 s26, 0x3dd53b95
    s_mov_b32 s27, 0x46800000
    s_lshl_b32 s95, s20, 12
    s_add_u32 s95, s95, 49152
    v_and_b32 v168, 31, v246
    v_lshrrev_b32 v169, 5, v246
    v_mov_b32 v241, 0xff800000
    v_lshlrev_b32 v170, 2, v169
    v_sub_u32 v170, v168, v170
    v_cmp_gt_i32 s[48:49], 0, v170
    v_cmp_gt_i32 s[50:51], 1, v170
    v_cmp_gt_i32 s[52:53], 2, v170
    v_cmp_gt_i32 s[54:55], 3, v170
    v_cmp_gt_i32 s[56:57], 8, v170
    v_cmp_gt_i32 s[58:59], 9, v170
    v_cmp_gt_i32 s[60:61], 10, v170
    v_cmp_gt_i32 s[62:63], 11, v170
    v_cmp_gt_i32 s[64:65], 16, v170
    v_cmp_gt_i32 s[66:67], 17, v170
    v_cmp_gt_i32 s[68:69], 18, v170
    v_cmp_gt_i32 s[70:71], 19, v170
    v_cmp_gt_i32 s[72:73], 24, v170
    v_cmp_gt_i32 s[74:75], 25, v170
    v_cmp_gt_i32 s[76:77], 26, v170
    v_cmp_gt_i32 s[78:79], 27, v170
    v_and_b32 v170, 7, v246
    v_lshlrev_b32 v172, 7, v168
    v_lshl_add_u32 v172, v170, 4, v172
    v_lshlrev_b32 v173, 5, v169
    v_xor_b32 v172, v172, v173
    v_add_u32 v230, s95, v172
    v_xor_b32 v231, 16, v230
    v_xor_b32 v232, 64, v230
    v_xor_b32 v233, 80, v230
    v_lshl_add_u32 v238, v246, 4, s95
    v_lshrrev_b32 v171, 3, v246
    v_xor_b32 v170, v170, v171
    v_mul_u32_u24 v172, 6144, v171
    v_lshl_add_u32 v239, v170, 4, v172
    v_cndmask_b32 v176, 0, v241, s[48:49]
    v_cndmask_b32 v177, 0, v241, s[50:51]
    v_cndmask_b32 v178, 0, v241, s[52:53]
    v_cndmask_b32 v179, 0, v241, s[54:55]
    v_cndmask_b32 v180, 0, v241, s[56:57]
    v_cndmask_b32 v181, 0, v241, s[58:59]
    v_cndmask_b32 v182, 0, v241, s[60:61]
    v_cndmask_b32 v183, 0, v241, s[62:63]
    v_cndmask_b32 v184, 0, v241, s[64:65]
    v_cndmask_b32 v185, 0, v241, s[66:67]
    v_cndmask_b32 v186, 0, v241, s[68:69]
    v_cndmask_b32 v187, 0, v241, s[70:71]
    v_cndmask_b32 v188, 0, v241, s[72:73]
    v_cndmask_b32 v189, 0, v241, s[74:75]
    v_cndmask_b32 v190, 0, v241, s[76:77]
    v_cndmask_b32 v191, 0, v241, s[78:79]
    s_add_u32 m0, s28, 9216
    s_add_u32 s80, s80, 49152
    buffer_load_dwordx4 v227, s[4:7], s80 offen offset:0 nt lds
    buffer_load_dwordx4 v228, s[4:7], s80 offen offset:1024 nt lds
    buffer_load_dwordx4 v229, s[4:7], s80 offen offset:2048 nt lds
    s_add_u32 m0, s24, 12288
    s_nop 0
    buffer_load_dwordx4 v7, s[8:11], s23 offen offset:0 lds
    buffer_load_dwordx4 v8, s[8:11], s23 offen offset:1024 lds
    buffer_load_dwordx4 v9, s[8:11], s23 offen offset:2048 lds
    s_waitcnt lgkmcnt(0)
    s_mov_b32 s10, s38
    s_mov_b32 s14, s38
    s_and_b32 s88, s32, 31
    s_lshl_b32 s43, s21, 1
    s_cmp_eq_u32 s88, 2
    s_addc_u32 s43, s43, 0
    s_add_u32 s88, s88, s21
    s_lshl2_add_u32 s25, s88, s30
    s_and_b32 s80, s32, 0xffffff80
    s_add_u32 s80, s80, s29
    s_add_u32 s81, s80, 49152
    s_add_u32 s82, s80, 98304
    s_add_u32 s83, s80, 147456
    s_mov_b32 s18, s33
    s_cmp_lg_u32 s34, 0
    s_cselect_b32 s41, 2, 0
    s_cselect_b32 s88, 12, 4
    s_cselect_b32 s90, s25, 4
    s_sub_u32 s40, s25, s88
    s_sub_u32 s42, s25, s90
    s_waitcnt vmcnt(15)
    s_barrier
    ds_read_b128 a[48:51], v1 offset:0
    ds_read_b128 a[52:55], v2 offset:0
    ds_read_b128 a[56:59], v3 offset:0
    ds_read_b128 a[60:63], v4 offset:0
    ds_read_b128 a[64:67], v1 offset:128
    ds_read_b128 a[68:71], v2 offset:128
    ds_read_b128 a[72:75], v3 offset:128
    ds_read_b128 a[76:79], v4 offset:128
    ds_read_b128 a[80:83], v1 offset:256
    ds_read_b128 a[84:87], v2 offset:256
    ds_read_b128 a[88:91], v3 offset:256
    ds_read_b128 a[92:95], v4 offset:256
    s_cmp_eq_u32 s20, 0
    s_cbranch_scc1 L_warm0
    s_cmp_eq_u32 s20, 1
    s_cbranch_scc1 L_warm1
    s_cmp_eq_u32 s20, 2
    s_cbranch_scc1 L_warm4
    s_branch L_warm2
L_warmb:
    s_add_u32 m0, s24, 24576
    s_nop 0
    buffer_load_dwordx4 v10, s[12:15], s22 offen offset:0 lds
    buffer_load_dwordx4 v11, s[12:15], s22 offen offset:1024 lds
    buffer_load_dwordx4 v12, s[12:15], s22 offen offset:2048 lds
    s_add_u32 m0, s24, 36864
    s_nop 0
    buffer_load_dwordx4 v10, s[12:15], s23 offen offset:0 lds
    buffer_load_dwordx4 v11, s[12:15], s23 offen offset:1024 lds
    buffer_load_dwordx4 v12, s[12:15], s23 offen offset:2048 lds
    s_mov_b64 s[22:23], s[36:37]
    s_xor_b32 s24, s24, 65536
    s_lshr_b32 s88, s32, 5
    s_and_b32 s88, s88, s21
    s_cbranch_scc1 L_feed1
L_pro:
    s_waitcnt vmcnt(9)
    s_nop 0
    ds_read_b128 a[0:3], v242 offset:0
    ds_read_b128 a[4:7], v243 offset:0
    ds_read_b128 a[8:11], v244 offset:0
    ds_read_b128 a[12:15], v245 offset:0
    v_xor_b32 v5, 65536, v5
    v_xor_b32 v6, 65536, v6
    s_add_u32 m0, s24, 0
    s_waitcnt lgkmcnt(3)
    v_mfma_f32_32x32x16_bf16 v[112:127], a[48:51], a[0:3], 0
    ds_read_b128 a[16:19], v242 offset:128
    ds_read_b128 a[20:23], v243 offset:128
    buffer_load_dwordx4 v7, s[8:11], s22 offen offset:0 lds
    s_waitcnt lgkmcnt(4)
    v_mfma_f32_32x32x16_bf16 v[112:127], a[52:55], a[4:7], v[112:127]
    ds_read_b128 a[24:27], v244 offset:128
    ds_read_b128 a[28:31], v245 offset:128
    buffer_load_dwordx4 v8, s[8:11], s22 offen offset:1024 lds
    s_waitcnt lgkmcnt(5)
    v_mfma_f32_32x32x16_bf16 v[112:127], a[56:59], a[8:11], v[112:127]
    ds_read_b128 a[32:35], v242 offset:256
    ds_read_b128 a[36:39], v243 offset:256
    buffer_load_dwordx4 v9, s[8:11], s22 offen offset:2048 lds
    s_waitcnt lgkmcnt(6)
    v_mfma_f32_32x32x16_bf16 v[112:127], a[60:63], a[12:15], v[112:127]
    ds_read_b128 a[40:43], v244 offset:256
    ds_read_b128 a[44:47], v245 offset:256
    s_add_u32 m0, s24, 24576
    s_waitcnt lgkmcnt(7)
    v_mfma_f32_32x32x16_bf16 v[112:127], a[64:67], a[16:19], v[112:127]
    buffer_load_dwordx4 v10, s[12:15], s22 offen offset:0 lds
    s_waitcnt lgkmcnt(6)
    v_mfma_f32_32x32x16_bf16 v[112:127], a[68:71], a[20:23], v[112:127]
    buffer_load_dwordx4 v11, s[12:15], s22 offen offset:1024 lds
    s_waitcnt lgkmcnt(5)
    v_mfma_f32_32x32x16_bf16 v[112:127], a[72:75], a[24:27], v[112:127]
    buffer_load_dwordx4 v12, s[12:15], s22 offen offset:2048 lds
    s_mov_b32 s22, s44
    s_waitcnt vmcnt(9)
    s_barrier
    ds_read_b128 a[48:51], v1 offset:12288
    ds_read_b128 a[52:55], v2 offset:12288
    s_waitcnt lgkmcnt(2)
    v_mfma_f32_32x32x16_bf16 v[112:127], a[76:79], a[28:31], v[112:127]
    ds_read_b128 a[56:59], v3 offset:12288
    ds_read_b128 a[60:63], v4 offset:12288
    ds_read_b64_tr_b16 a[96:97], v5 offset:24576
    v_mfma_f32_32x32x16_bf16 v[112:127], a[80:83], a[32:35], v[112:127]
    ds_read_b128 a[64:67], v1 offset:12416
    ds_read_b128 a[68:71], v2 offset:12416
    ds_read_b64_tr_b16 a[98:99], v5 offset:27648
    v_mfma_f32_32x32x16_bf16 v[112:127], a[84:87], a[36:39], v[112:127]
    ds_read_b128 a[72:75], v3 offset:12416
    ds_read_b128 a[76:79], v4 offset:12416
    ds_read_b64_tr_b16 a[100:101], v6 offset:24640
    v_mfma_f32_32x32x16_bf16 v[112:127], a[88:91], a[40:43], v[112:127]
    ds_read_b128 a[80:83], v1 offset:12544
    ds_read_b128 a[84:87], v2 offset:12544
    ds_read_b64_tr_b16 a[102:103], v6 offset:27712
    v_mfma_f32_32x32x16_bf16 v[112:127], a[92:95], a[44:47], v[112:127]
    ds_read_b128 a[88:91], v3 offset:12544
    ds_read_b128 a[92:95], v4 offset:12544
    ds_read_b64_tr_b16 a[104:105], v5 offset:24704
    s_waitcnt lgkmcnt(10)
    s_nop 0
    v_mfma_f32_32x32x16_bf16 v[128:143], a[48:51], a[0:3], 0
    ds_read_b64_tr_b16 a[106:107], v5 offset:27776
    ds_read_b64_tr_b16 a[108:109], v6 offset:24768
    ds_read_b64_tr_b16 a[110:111], v6 offset:27840
    ds_read_b64_tr_b16 a[112:113], v5 offset:24832
    ds_read_b64_tr_b16 a[114:115], v5 offset:27904
    v_mfma_f32_32x32x16_bf16 v[128:143], a[52:55], a[4:7], v[128:143]
    s_add_u32 m0, s24, 12288
    ds_read_b64_tr_b16 a[116:117], v6 offset:24896
    s_nop 1
    s_nop 0
L_maskbP1:
    v_max3_f32 v168, v112, v113, v114
    v_max3_f32 v169, v115, v116, v117
    v_max3_f32 v168, v168, v118, v119
    v_max3_f32 v169, v169, v120, v121
    v_max3_f32 v168, v168, v122, v123
    v_max3_f32 v169, v169, v124, v125
    v_max3_f32 v168, v168, v126, v127
    v_max_f32_e64 v168, v168, v169
    v_mfma_f32_32x32x16_bf16 v[128:143], a[56:59], a[8:11], v[128:143]
    buffer_load_dwordx4 v7, s[8:11], s23 offen offset:0 lds
    ds_read_b64_tr_b16 a[118:119], v6 offset:27968
    ds_read_b64_tr_b16 a[120:121], v5 offset:30720
    v_mov_b32_e64 v169, v168
    s_nop 1
    v_permlane32_swap_b32 v168, v169
    v_max_f32 v168, v168, v169
    v_mul_f32 v13, s26, v168
    v_fma_f32 v160, v112, s26, -v13
    v_fma_f32 v161, v113, s26, -v13
    v_exp_f32_e64 v160, v160
    v_fma_f32 v162, v114, s26, -v13
    v_mfma_f32_32x32x16_bf16 v[128:143], a[60:63], a[12:15], v[128:143]
    buffer_load_dwordx4 v8, s[8:11], s23 offen offset:1024 lds
    ds_read_b64_tr_b16 a[122:123], v5 offset:33792
    ds_read_b64_tr_b16 a[124:125], v6 offset:30784
    v_exp_f32_e64 v161, v161
    v_fma_f32 v163, v115, s26, -v13
    v_exp_f32_e64 v162, v162
    v_fma_f32 v164, v116, s26, -v13
    v_add_f32_e64 v15, v160, v161
    v_cvt_pk_bf16_f32 v144, v160, v161
    v_mfma_f32_32x32x16_bf16 v[128:143], a[64:67], a[16:19], v[128:143]
    buffer_load_dwordx4 v9, s[8:11], s23 offen offset:2048 lds
    ds_read_b64_tr_b16 a[126:127], v6 offset:33856
    v_exp_f32_e64 v163, v163
    v_fma_f32 v165, v117, s26, -v13
    v_add_f32 v15, v15, v162
    v_exp_f32 v164, v164
    v_fma_f32 v166, v118, s26, -v13
    v_add_f32_e64 v15, v15, v163
    v_mfma_f32_32x32x16_bf16 v[128:143], a[68:71], a[20:23], v[128:143]
    s_add_u32 m0, s24, 36864
    ds_read_b64_tr_b16 a[128:129], v5 offset:30848
    ds_read_b64_tr_b16 a[130:131], v5 offset:33920
    v_cvt_pk_bf16_f32 v145, v162, v163
    v_exp_f32_e64 v165, v165
    v_fma_f32 v167, v119, s26, -v13
    v_add_f32 v15, v15, v164
    v_exp_f32 v166, v166
    v_fma_f32 v160, v120, s26, -v13
    s_waitcnt lgkmcnt(14)
    v_mfma_f32_32x32x16_bf16 v[128:143], a[72:75], a[24:27], v[128:143]
    buffer_load_dwordx4 v10, s[12:15], s23 offen offset:0 lds
    ds_read_b64_tr_b16 a[132:133], v6 offset:30912
    v_add_f32 v15, v15, v165
    v_cvt_pk_bf16_f32 v146, v164, v165
    v_exp_f32_e64 v167, v167
    v_fma_f32 v161, v121, s26, -v13
    v_add_f32 v15, v15, v166
    v_exp_f32 v160, v160
    v_mfma_f32_32x32x16_bf16 v[128:143], a[76:79], a[28:31], v[128:143]
    buffer_load_dwordx4 v11, s[12:15], s23 offen offset:1024 lds
    ds_read_b64_tr_b16 a[134:135], v6 offset:33984
    ds_read_b64_tr_b16 a[136:137], v5 offset:30976
    v_fma_f32 v162, v122, s26, -v13
    v_add_f32_e64 v15, v15, v167
    v_cvt_pk_bf16_f32 v147, v166, v167
    v_exp_f32_e64 v161, v161
    v_fma_f32 v163, v123, s26, -v13
    v_add_f32_e64 v15, v15, v160
    v_mfma_f32_32x32x16_bf16 v[128:143], a[80:83], a[32:35], v[128:143]
    buffer_load_dwordx4 v12, s[12:15], s23 offen offset:2048 lds
    s_xor_b32 s24, s24, 65536
    ds_read_b64_tr_b16 a[138:139], v5 offset:34048
    v_exp_f32_e64 v162, v162
    v_fma_f32 v164, v124, s26, -v13
    v_add_f32_e64 v15, v15, v161
    v_cvt_pk_bf16_f32 v148, v160, v161
    v_exp_f32_e64 v163, v163
    v_fma_f32 v165, v125, s26, -v13
    v_mfma_f32_32x32x16_bf16 v[128:143], a[84:87], a[36:39], v[128:143]
    s_and_b32 m0, s24, 0xfffff
    s_load_dword s23, s[96:97], s30 offset:4
    buffer_load_dwordx4 v7, s[8:11], s22 offen offset:0 lds
    ds_read_b64_tr_b16 a[140:141], v6 offset:31040
    v_add_f32 v15, v15, v162
    v_exp_f32 v164, v164
    v_fma_f32 v166, v126, s26, -v13
    v_add_f32_e64 v15, v15, v163
    v_cvt_pk_bf16_f32 v149, v162, v163
    v_exp_f32_e64 v165, v165
    v_mfma_f32_32x32x16_bf16 v[128:143], a[88:91], a[40:43], v[128:143]
    buffer_load_dwordx4 v8, s[8:11], s22 offen offset:1024 lds
    s_add_u32 s30, s30, 8
    ds_read_b64_tr_b16 a[142:143], v6 offset:34112
    v_fma_f32 v167, v127, s26, -v13
    v_add_f32 v15, v15, v164
    v_exp_f32_e64 v166, v166
    v_exp_f32 v167, v167
    v_add_f32 v15, v15, v165
    v_cvt_pk_bf16_f32 v150, v164, v165
    v_mfma_f32_32x32x16_bf16 v[128:143], a[92:95], a[44:47], v[128:143]
    buffer_load_dwordx4 v9, s[8:11], s22 offen offset:2048 lds
    v_add_f32 v15, v15, v166
    v_add_f32 v15, v15, v167
    v_cvt_pk_bf16_f32 v151, v166, v167
    v_xor_b32 v1, 65536, v1
    v_xor_b32 v2, 65536, v2
    v_xor_b32 v3, 65536, v3
    v_xor_b32 v4, 65536, v4
    v_mov_b32 v14, v15
    s_waitcnt lgkmcnt(0)
L_first:
    s_waitcnt vmcnt(12) lgkmcnt(0)
    s_barrier
    v_mfma_f32_32x32x16_bf16 v[16:31], a[96:99], v[144:147], 0
    ds_read_b128 a[48:51], v1 offset:0
    ds_read_b128 a[52:55], v2 offset:0
    s_add_u32 m0, s24, 24576
    v_mfma_f32_32x32x16_bf16 v[32:47], a[100:103], v[144:147], 0
    ds_read_b128 a[56:59], v3 offset:0
    ds_read_b64_tr_b16 a[96:97], v5 offset:36864
    v_fma_f32 v160, v128, s26, -v13
    v_fma_f32 v161, v129, s26, -v13
    v_exp_f32_e64 v160, v160
    v_mfma_f32_32x32x16_bf16 v[48:63], a[104:107], v[144:147], 0
    ds_read_b128 a[60:63], v4 offset:0
    buffer_load_dwordx4 v10, s[12:15], s22 offen offset:0 lds
    v_fma_f32 v162, v130, s26, -v13
    v_exp_f32_e64 v161, v161
    v_mfma_f32_32x32x16_bf16 v[64:79], a[108:111], v[144:147], 0
    ds_read_b64_tr_b16 a[98:99], v5 offset:39936
    ds_read_b64_tr_b16 a[100:101], v6 offset:36928
    v_fma_f32 v163, v131, s26, -v13
    v_exp_f32_e64 v162, v162
    v_fma_f32 v164, v132, s26, -v13
    v_mfma_f32_32x32x16_bf16 v[80:95], a[112:115], v[144:147], 0
    ds_read_b128 a[64:67], v1 offset:128
    buffer_load_dwordx4 v11, s[12:15], s22 offen offset:1024 lds
    v_add_f32_e64 v15, v160, v161
    v_cvt_pk_bf16_f32 v152, v160, v161
    v_exp_f32_e64 v163, v163
    v_mfma_f32_32x32x16_bf16 v[96:111], a[116:119], v[144:147], 0
    ds_read_b128 a[68:71], v2 offset:128
    ds_read_b64_tr_b16 a[102:103], v6 offset:40000
    v_fma_f32 v165, v133, s26, -v13
    v_add_f32 v15, v15, v162
    v_exp_f32 v164, v164
    v_mfma_f32_32x32x16_bf16 v[16:31], a[120:123], v[148:151], v[16:31]
    ds_read_b128 a[72:75], v3 offset:128
    buffer_load_dwordx4 v12, s[12:15], s22 offen offset:2048 lds
    v_fma_f32 v166, v134, s26, -v13
    v_add_f32_e64 v15, v15, v163
    v_cvt_pk_bf16_f32 v153, v162, v163
    v_mfma_f32_32x32x16_bf16 v[32:47], a[124:127], v[148:151], v[32:47]
    ds_read_b128 a[76:79], v4 offset:128
    s_load_dword s22, s[96:97], s30
    v_exp_f32_e64 v165, v165
    v_fma_f32 v167, v135, s26, -v13
    v_mfma_f32_32x32x16_bf16 v[48:63], a[128:131], v[148:151], v[48:63]
    ds_read_b128 a[80:83], v1 offset:256
    s_add_u32 m0, s24, 12288
    v_add_f32 v15, v15, v164
    v_exp_f32 v166, v166
    v_fma_f32 v160, v136, s26, -v13
    v_mfma_f32_32x32x16_bf16 v[64:79], a[132:135], v[148:151], v[64:79]
    ds_read_b64_tr_b16 a[104:105], v5 offset:36992
    ds_read_b64_tr_b16 a[106:107], v5 offset:40064
    v_add_f32_e64 v15, v15, v165
    v_cvt_pk_bf16_f32 v154, v164, v165
    v_exp_f32_e64 v167, v167
    v_mfma_f32_32x32x16_bf16 v[80:95], a[136:139], v[148:151], v[80:95]
    v_fma_f32 v161, v137, s26, -v13
    v_add_f32 v15, v15, v166
    v_exp_f32 v160, v160
    v_mfma_f32_32x32x16_bf16 v[96:111], a[140:143], v[148:151], v[96:111]
    s_cmp_eq_u32 s43, 2
    s_cbranch_scc1 L_pos1
    s_waitcnt lgkmcnt(2)
    v_mfma_f32_32x32x16_bf16 v[112:127], a[48:51], a[0:3], v[176:191]
    s_branch L_pos1b
L_pre:
.p2align 12
L_warm0:
    s_branch L_warmb
L_pos1:
    s_waitcnt lgkmcnt(2)
    v_mfma_f32_32x32x16_bf16 v[112:127], a[48:51], a[0:3], 0
L_pos1b:
    ds_read_b64_tr_b16 a[108:109], v6 offset:37056
    ds_read_b64_tr_b16 a[110:111], v6 offset:40128
    ds_read_b64_tr_b16 a[112:113], v5 offset:37120
    v_fma_f32 v162, v138, s26, -v13
    v_add_f32_e64 v15, v15, v167
    v_cvt_pk_bf16_f32 v155, v166, v167
    v_mfma_f32_32x32x16_bf16 v[112:127], a[52:55], a[4:7], v[112:127]
    ds_read_b64_tr_b16 a[114:115], v5 offset:40192
    ds_read_b64_tr_b16 a[116:117], v6 offset:37184
    ds_read_b64_tr_b16 a[118:119], v6 offset:40256
    v_exp_f32_e64 v161, v161
    v_fma_f32 v163, v139, s26, -v13
    v_mfma_f32_32x32x16_bf16 v[112:127], a[56:59], a[8:11], v[112:127]
    ds_read_b128 a[84:87], v2 offset:256
    buffer_load_dwordx4 v7, s[8:11], s23 offen offset:0 lds
    v_add_f32 v15, v15, v160
    v_exp_f32 v162, v162
    v_mfma_f32_32x32x16_bf16 v[112:127], a[60:63], a[12:15], v[112:127]
    ds_read_b64_tr_b16 a[120:121], v5 offset:43008
    ds_read_b64_tr_b16 a[122:123], v5 offset:46080
    ds_read_b64_tr_b16 a[124:125], v6 offset:43072
    v_fma_f32 v164, v140, s26, -v13
    v_add_f32_e64 v15, v15, v161
    v_cvt_pk_bf16_f32 v156, v160, v161
    v_mfma_f32_32x32x16_bf16 v[112:127], a[64:67], a[16:19], v[112:127]
    ds_read_b128 a[88:91], v3 offset:256
    buffer_load_dwordx4 v8, s[8:11], s23 offen offset:1024 lds
    v_exp_f32_e64 v163, v163
    v_fma_f32 v165, v141, s26, -v13
    v_mfma_f32_32x32x16_bf16 v[112:127], a[68:71], a[20:23], v[112:127]
    ds_read_b64_tr_b16 a[126:127], v6 offset:46144
    ds_read_b64_tr_b16 a[128:129], v5 offset:43136
    ds_read_b64_tr_b16 a[130:131], v5 offset:46208
    v_add_f32 v15, v15, v162
    v_exp_f32 v164, v164
    v_mfma_f32_32x32x16_bf16 v[112:127], a[72:75], a[24:27], v[112:127]
    ds_read_b128 a[92:95], v4 offset:256
    buffer_load_dwordx4 v9, s[8:11], s23 offen offset:2048 lds
    v_fma_f32 v166, v142, s26, -v13
    v_add_f32_e64 v15, v15, v163
    v_cvt_pk_bf16_f32 v157, v162, v163
    v_mfma_f32_32x32x16_bf16 v[112:127], a[76:79], a[28:31], v[112:127]
    ds_read_b64_tr_b16 a[132:133], v6 offset:43200
    ds_read_b64_tr_b16 a[134:135], v6 offset:46272
    v_exp_f32_e64 v165, v165
    v_fma_f32 v167, v143, s26, -v13
    v_mfma_f32_32x32x16_bf16 v[112:127], a[80:83], a[32:35], v[112:127]
    ds_read_b64_tr_b16 a[136:137], v5 offset:43264
    ds_read_b64_tr_b16 a[138:139], v5 offset:46336
    v_add_f32_e64 v15, v15, v164
    v_exp_f32 v166, v166
    s_waitcnt lgkmcnt(4)
    v_mfma_f32_32x32x16_bf16 v[112:127], a[84:87], a[36:39], v[112:127]
    ds_read_b64_tr_b16 a[140:141], v6 offset:43328
    ds_read_b64_tr_b16 a[142:143], v6 offset:46400
    v_exp_f32 v167, v167
    v_add_f32 v15, v15, v165
    v_cvt_pk_bf16_f32 v158, v164, v165
    v_mfma_f32_32x32x16_bf16 v[112:127], a[88:91], a[40:43], v[112:127]
    v_add_f32 v15, v15, v166
    v_add_f32 v15, v15, v167
    v_cvt_pk_bf16_f32 v159, v166, v167
    v_cmp_lt_f32_e64 vcc, s27, v15
    v_mfma_f32_32x32x16_bf16 v[112:127], a[92:95], a[44:47], v[112:127]
    s_cbranch_vccnz L_rare1
L_back1:
    s_waitcnt vmcnt(12) lgkmcnt(0)
    s_barrier
    v_mfma_f32_32x32x16_bf16 v[16:31], a[96:99], v[152:155], v[16:31]
    ds_read_b128 a[48:51], v1 offset:12288
    ds_read_b128 a[52:55], v2 offset:12288
    s_add_u32 m0, s24, 36864
    v_add_f32 v14, v14, v15
    v_xor_b32 v5, 65536, v5
    v_xor_b32 v6, 65536, v6
    v_mfma_f32_32x32x16_bf16 v[32:47], a[100:103], v[152:155], v[32:47]
    ds_read_b128 a[56:59], v3 offset:12288
    v_fma_f32 v160, v112, s26, -v13
    v_fma_f32 v161, v113, s26, -v13
    v_exp_f32_e64 v160, v160
    v_fma_f32 v162, v114, s26, -v13
    v_mfma_f32_32x32x16_bf16 v[48:63], a[104:107], v[152:155], v[48:63]
    ds_read_b128 a[60:63], v4 offset:12288
    buffer_load_dwordx4 v10, s[12:15], s23 offen offset:0 lds
    v_exp_f32_e64 v161, v161
    v_fma_f32 v163, v115, s26, -v13
    v_mfma_f32_32x32x16_bf16 v[64:79], a[108:111], v[152:155], v[64:79]
    ds_read_b64_tr_b16 a[96:97], v5 offset:24576
    ds_read_b64_tr_b16 a[98:99], v5 offset:27648
    v_exp_f32_e64 v162, v162
    v_fma_f32 v164, v116, s26, -v13
    v_add_f32_e64 v15, v160, v161
    v_mfma_f32_32x32x16_bf16 v[80:95], a[112:115], v[152:155], v[80:95]
    ds_read_b128 a[64:67], v1 offset:12416
    buffer_load_dwordx4 v11, s[12:15], s23 offen offset:1024 lds
    v_cvt_pk_bf16_f32 v144, v160, v161
    v_exp_f32_e64 v163, v163
    v_mfma_f32_32x32x16_bf16 v[96:111], a[116:119], v[152:155], v[96:111]
    ds_read_b128 a[68:71], v2 offset:12416
    v_fma_f32 v165, v117, s26, -v13
    v_add_f32 v15, v15, v162
    v_exp_f32 v164, v164
    v_mfma_f32_32x32x16_bf16 v[16:31], a[120:123], v[156:159], v[16:31]
    ds_read_b128 a[72:75], v3 offset:12416
    buffer_load_dwordx4 v12, s[12:15], s23 offen offset:2048 lds
    v_fma_f32 v166, v118, s26, -v13
    v_add_f32_e64 v15, v15, v163
    v_cvt_pk_bf16_f32 v145, v162, v163
    v_mfma_f32_32x32x16_bf16 v[32:47], a[124:127], v[156:159], v[32:47]
    ds_read_b128 a[76:79], v4 offset:12416
    s_load_dword s23, s[96:97], s30 offset:4
    v_exp_f32_e64 v165, v165
    v_fma_f32 v167, v119, s26, -v13
    v_add_f32_e64 v15, v15, v164
    v_mfma_f32_32x32x16_bf16 v[48:63], a[128:131], v[156:159], v[48:63]
    ds_read_b128 a[80:83], v1 offset:12544
    s_add_u32 s30, s30, 8
    v_exp_f32 v166, v166
    v_fma_f32 v160, v120, s26, -v13
    v_add_f32_e64 v15, v15, v165
    v_mfma_f32_32x32x16_bf16 v[64:79], a[132:135], v[156:159], v[64:79]
    ds_read_b64_tr_b16 a[100:101], v6 offset:24640
    ds_read_b64_tr_b16 a[102:103], v6 offset:27712
    s_xor_b32 s24, s24, 65536
    v_cvt_pk_bf16_f32 v146, v164, v165
    v_exp_f32_e64 v167, v167
    v_mfma_f32_32x32x16_bf16 v[80:95], a[136:139], v[156:159], v[80:95]
    ds_read_b64_tr_b16 a[104:105], v5 offset:24704
    ds_read_b64_tr_b16 a[106:107], v5 offset:27776
    s_cmp_ge_u32 s30, s40
    v_fma_f32 v161, v121, s26, -v13
    v_add_f32 v15, v15, v166
    v_exp_f32_e64 v160, v160
    v_mfma_f32_32x32x16_bf16 v[96:111], a[140:143], v[156:159], v[96:111]
    ds_read_b64_tr_b16 a[108:109], v6 offset:24768
    ds_read_b64_tr_b16 a[110:111], v6 offset:27840
    s_cbranch_scc1 L_special
L_loop:
    s_waitcnt lgkmcnt(6)
    v_mfma_f32_32x32x16_bf16 v[128:143], a[48:51], a[0:3], 0
    ds_read_b64_tr_b16 a[112:113], v5 offset:24832
    ds_read_b64_tr_b16 a[114:115], v5 offset:27904
    ds_read_b64_tr_b16 a[116:117], v6 offset:24896
    v_fma_f32 v162, v122, s26, -v13
    v_add_f32_e64 v15, v15, v167
    v_cvt_pk_bf16_f32 v147, v166, v167
    v_mfma_f32_32x32x16_bf16 v[128:143], a[52:55], a[4:7], v[128:143]
    ds_read_b64_tr_b16 a[118:119], v6 offset:27968
    s_add_u32 m0, s24, 0
    v_exp_f32 v161, v161
    v_fma_f32 v163, v123, s26, -v13
    v_add_f32_e64 v15, v15, v160
    v_mfma_f32_32x32x16_bf16 v[128:143], a[56:59], a[8:11], v[128:143]
    ds_read_b128 a[84:87], v2 offset:12544
    buffer_load_dwordx4 v7, s[8:11], s22 offen offset:0 lds
    v_exp_f32_e64 v162, v162
    v_fma_f32 v164, v124, s26, -v13
    v_mfma_f32_32x32x16_bf16 v[128:143], a[60:63], a[12:15], v[128:143]
    ds_read_b64_tr_b16 a[120:121], v5 offset:30720
    ds_read_b64_tr_b16 a[122:123], v5 offset:33792
    ds_read_b64_tr_b16 a[124:125], v6 offset:30784
    v_add_f32_e64 v15, v15, v161
    v_cvt_pk_bf16_f32 v148, v160, v161
    v_exp_f32_e64 v163, v163
    v_mfma_f32_32x32x16_bf16 v[128:143], a[64:67], a[16:19], v[128:143]
    ds_read_b128 a[88:91], v3 offset:12544
    buffer_load_dwordx4 v8, s[8:11], s22 offen offset:1024 lds
    v_fma_f32 v165, v125, s26, -v13
    v_add_f32 v15, v15, v162
    v_exp_f32 v164, v164
    v_mfma_f32_32x32x16_bf16 v[128:143], a[68:71], a[20:23], v[128:143]
    ds_read_b64_tr_b16 a[126:127], v6 offset:33856
    ds_read_b64_tr_b16 a[128:129], v5 offset:30848
    ds_read_b64_tr_b16 a[130:131], v5 offset:33920
    v_fma_f32 v166, v126, s26, -v13
    v_add_f32_e64 v15, v15, v163
    v_cvt_pk_bf16_f32 v149, v162, v163
    v_mfma_f32_32x32x16_bf16 v[128:143], a[72:75], a[24:27], v[128:143]
    ds_read_b128 a[92:95], v4 offset:12544
    buffer_load_dwordx4 v9, s[8:11], s22 offen offset:2048 lds
    v_exp_f32_e64 v165, v165
    v_fma_f32 v167, v127, s26, -v13
    v_mfma_f32_32x32x16_bf16 v[128:143], a[76:79], a[28:31], v[128:143]
    ds_read_b64_tr_b16 a[132:133], v6 offset:30912
    ds_read_b64_tr_b16 a[134:135], v6 offset:33984
    v_add_f32 v15, v15, v164
    v_exp_f32 v166, v166
    v_mfma_f32_32x32x16_bf16 v[128:143], a[80:83], a[32:35], v[128:143]
    ds_read_b64_tr_b16 a[136:137], v5 offset:30976
    ds_read_b64_tr_b16 a[138:139], v5 offset:34048
    v_exp_f32_e64 v167, v167
    v_add_f32 v15, v15, v165
    s_waitcnt lgkmcnt(4)
    v_mfma_f32_32x32x16_bf16 v[128:143], a[84:87], a[36:39], v[128:143]
    ds_read_b64_tr_b16 a[140:141], v6 offset:31040
    ds_read_b64_tr_b16 a[142:143], v6 offset:34112
    v_cvt_pk_bf16_f32 v150, v164, v165
    v_add_f32_e64 v15, v15, v166
    v_xor_b32 v1, 65536, v1
    v_mfma_f32_32x32x16_bf16 v[128:143], a[88:91], a[40:43], v[128:143]
    v_xor_b32 v2, 65536, v2
    v_add_f32_e64 v15, v15, v167
    v_cvt_pk_bf16_f32 v151, v166, v167
    v_cmp_lt_f32_e64 vcc, s27, v15
    v_mfma_f32_32x32x16_bf16 v[128:143], a[92:95], a[44:47], v[128:143]
    s_cbranch_vccnz L_rare0
L_back0:
    s_waitcnt vmcnt(12) lgkmcnt(0)
    s_barrier
    v_mfma_f32_32x32x16_bf16 v[16:31], a[96:99], v[144:147], v[16:31]
    ds_read_b128 a[48:51], v1 offset:0
    ds_read_b128 a[52:55], v2 offset:0
    s_add_u32 m0, s24, 24576
    v_add_f32 v14, v14, v15
    v_xor_b32 v3, 65536, v3
    v_xor_b32 v4, 65536, v4
    v_mfma_f32_32x32x16_bf16 v[32:47], a[100:103], v[144:147], v[32:47]
    ds_read_b128 a[56:59], v3 offset:0
    ds_read_b64_tr_b16 a[96:97], v5 offset:36864
    v_fma_f32 v160, v128, s26, -v13
    v_fma_f32 v161, v129, s26, -v13
    v_exp_f32_e64 v160, v160
    v_mfma_f32_32x32x16_bf16 v[48:63], a[104:107], v[144:147], v[48:63]
    ds_read_b128 a[60:63], v4 offset:0
    buffer_load_dwordx4 v10, s[12:15], s22 offen offset:0 lds
    v_fma_f32 v162, v130, s26, -v13
    v_exp_f32_e64 v161, v161
    v_mfma_f32_32x32x16_bf16 v[64:79], a[108:111], v[144:147], v[64:79]
    ds_read_b64_tr_b16 a[98:99], v5 offset:39936
    ds_read_b64_tr_b16 a[100:101], v6 offset:36928
    v_fma_f32 v163, v131, s26, -v13
    v_exp_f32_e64 v162, v162
    v_fma_f32 v164, v132, s26, -v13
    v_mfma_f32_32x32x16_bf16 v[80:95], a[112:115], v[144:147], v[80:95]
    ds_read_b128 a[64:67], v1 offset:128
    buffer_load_dwordx4 v11, s[12:15], s22 offen offset:1024 lds
    v_add_f32_e64 v15, v160, v161
    v_cvt_pk_bf16_f32 v152, v160, v161
    v_exp_f32_e64 v163, v163
    v_mfma_f32_32x32x16_bf16 v[96:111], a[116:119], v[144:147], v[96:111]
    ds_read_b128 a[68:71], v2 offset:128
    ds_read_b64_tr_b16 a[102:103], v6 offset:40000
    v_fma_f32 v165, v133, s26, -v13
    v_add_f32 v15, v15, v162
    v_exp_f32 v164, v164
    v_mfma_f32_32x32x16_bf16 v[16:31], a[120:123], v[148:151], v[16:31]
    ds_read_b128 a[72:75], v3 offset:128
    buffer_load_dwordx4 v12, s[12:15], s22 offen offset:2048 lds
    v_fma_f32 v166, v134, s26, -v13
    v_add_f32_e64 v15, v15, v163
    v_cvt_pk_bf16_f32 v153, v162, v163
    v_mfma_f32_32x32x16_bf16 v[32:47], a[124:127], v[148:151], v[32:47]
    ds_read_b128 a[76:79], v4 offset:128
    s_load_dword s22, s[96:97], s30
    v_exp_f32_e64 v165, v165
    v_fma_f32 v167, v135, s26, -v13
    v_mfma_f32_32x32x16_bf16 v[48:63], a[128:131], v[148:151], v[48:63]
    ds_read_b128 a[80:83], v1 offset:256
    s_add_u32 m0, s24, 12288
    v_add_f32 v15, v15, v164
    v_exp_f32 v166, v166
    v_fma_f32 v160, v136, s26, -v13
    v_mfma_f32_32x32x16_bf16 v[64:79], a[132:135], v[148:151], v[64:79]
    ds_read_b64_tr_b16 a[104:105], v5 offset:36992
    ds_read_b64_tr_b16 a[106:107], v5 offset:40064
    v_add_f32_e64 v15, v15, v165
    v_cvt_pk_bf16_f32 v154, v164, v165
    v_exp_f32_e64 v167, v167
    v_mfma_f32_32x32x16_bf16 v[80:95], a[136:139], v[148:151], v[80:95]
    v_fma_f32 v161, v137, s26, -v13
    v_add_f32 v15, v15, v166
    v_exp_f32 v160, v160
    v_mfma_f32_32x32x16_bf16 v[96:111], a[140:143], v[148:151], v[96:111]
    s_branch L_pos1
L_warm4:
    s_branch L_warmb
L_special:
    s_cmp_lg_u32 s30, s42
    s_cbranch_scc1 L_disp
L_last:
    s_waitcnt lgkmcnt(6)
    v_mfma_f32_32x32x16_bf16 v[128:143], a[48:51], a[0:3], v[176:191]
    ds_read_b64_tr_b16 a[112:113], v5 offset:24832
    ds_read_b64_tr_b16 a[114:115], v5 offset:27904
    ds_read_b64_tr_b16 a[116:117], v6 offset:24896
    v_fma_f32 v162, v122, s26, -v13
    v_add_f32 v15, v15, v167
    v_cvt_pk_bf16_f32 v147, v166, v167
    v_mfma_f32_32x32x16_bf16 v[128:143], a[52:55], a[4:7], v[128:143]
    ds_read_b64_tr_b16 a[118:119], v6 offset:27968
    s_add_u32 m0, s24, 0
    v_exp_f32 v161, v161
    v_fma_f32 v163, v123, s26, -v13
    v_add_f32_e64 v15, v15, v160
    v_mfma_f32_32x32x16_bf16 v[128:143], a[56:59], a[8:11], v[128:143]
    ds_read_b128 a[84:87], v2 offset:12544
    buffer_load_dwordx4 v7, s[8:11], s22 offen offset:0 lds
    v_exp_f32_e64 v162, v162
    v_fma_f32 v164, v124, s26, -v13
    v_mfma_f32_32x32x16_bf16 v[128:143], a[60:63], a[12:15], v[128:143]
    ds_read_b64_tr_b16 a[120:121], v5 offset:30720
    ds_read_b64_tr_b16 a[122:123], v5 offset:33792
    ds_read_b64_tr_b16 a[124:125], v6 offset:30784
    v_add_f32_e64 v15, v15, v161
    v_cvt_pk_bf16_f32 v148, v160, v161
    v_exp_f32_e64 v163, v163
    v_mfma_f32_32x32x16_bf16 v[128:143], a[64:67], a[16:19], v[128:143]
    ds_read_b128 a[88:91], v3 offset:12544
    buffer_load_dwordx4 v8, s[8:11], s22 offen offset:1024 lds
    v_fma_f32 v165, v125, s26, -v13
    v_add_f32 v15, v15, v162
    v_exp_f32 v164, v164
    v_mfma_f32_32x32x16_bf16 v[128:143], a[68:71], a[20:23], v[128:143]
    ds_read_b64_tr_b16 a[126:127], v6 offset:33856
    ds_read_b64_tr_b16 a[128:129], v5 offset:30848
    ds_read_b64_tr_b16 a[130:131], v5 offset:33920
    v_fma_f32 v166, v126, s26, -v13
    v_add_f32_e64 v15, v15, v163
    v_cvt_pk_bf16_f32 v149, v162, v163
    v_mfma_f32_32x32x16_bf16 v[128:143], a[72:75], a[24:27], v[128:143]
    ds_read_b128 a[92:95], v4 offset:12544
    buffer_load_dwordx4 v9, s[8:11], s22 offen offset:2048 lds
    v_exp_f32_e64 v165, v165
    v_fma_f32 v167, v127, s26, -v13
    v_mfma_f32_32x32x16_bf16 v[128:143], a[76:79], a[28:31], v[128:143]
    ds_read_b64_tr_b16 a[132:133], v6 offset:30912
    ds_read_b64_tr_b16 a[134:135], v6 offset:33984
    v_add_f32 v15, v15, v164
    v_exp_f32 v166, v166
    v_mfma_f32_32x32x16_bf16 v[128:143], a[80:83], a[32:35], v[128:143]
    ds_read_b64_tr_b16 a[136:137], v5 offset:30976
    ds_read_b64_tr_b16 a[138:139], v5 offset:34048
    v_exp_f32_e64 v167, v167
    v_add_f32 v15, v15, v165
    s_waitcnt lgkmcnt(4)
    v_mfma_f32_32x32x16_bf16 v[128:143], a[84:87], a[36:39], v[128:143]
    ds_read_b64_tr_b16 a[140:141], v6 offset:31040
    ds_read_b64_tr_b16 a[142:143], v6 offset:34112
    v_cvt_pk_bf16_f32 v150, v164, v165
    v_add_f32_e64 v15, v15, v166
    v_xor_b32 v1, 65536, v1
    v_mfma_f32_32x32x16_bf16 v[128:143], a[88:91], a[40:43], v[128:143]
    v_xor_b32 v2, 65536, v2
    v_add_f32_e64 v15, v15, v167
    v_cvt_pk_bf16_f32 v151, v166, v167
    v_cmp_lt_f32_e64 vcc, s27, v15
    v_mfma_f32_32x32x16_bf16 v[128:143], a[92:95], a[44:47], v[128:143]
    s_cbranch_vccnz L_rareL
L_backL:
    s_waitcnt vmcnt(12) lgkmcnt(0)
    s_barrier
    v_mfma_f32_32x32x16_bf16 v[16:31], a[96:99], v[144:147], v[16:31]
    s_add_u32 m0, s24, 24576
    v_add_f32 v14, v14, v15
    v_xor_b32 v3, 65536, v3
    v_xor_b32 v4, 65536, v4
    s_nop 1
    v_mfma_f32_32x32x16_bf16 v[32:47], a[100:103], v[144:147], v[32:47]
    buffer_load_dwordx4 v10, s[12:15], s22 offen offset:0 lds
    v_fma_f32 v160, v128, s26, -v13
    v_fma_f32 v161, v129, s26, -v13
    v_exp_f32 v160, v160
    v_fma_f32 v162, v130, s26, -v13
    v_mfma_f32_32x32x16_bf16 v[48:63], a[104:107], v[144:147], v[48:63]
    ds_read_b64_tr_b16 a[96:97], v5 offset:36864
    ds_read_b64_tr_b16 a[98:99], v5 offset:39936
    v_exp_f32_e64 v161, v161
    v_fma_f32 v163, v131, s26, -v13
    v_exp_f32_e64 v162, v162
    v_mfma_f32_32x32x16_bf16 v[64:79], a[108:111], v[144:147], v[64:79]
    buffer_load_dwordx4 v11, s[12:15], s22 offen offset:1024 lds
    v_fma_f32 v164, v132, s26, -v13
    v_add_f32_e64 v15, v160, v161
    v_cvt_pk_bf16_f32 v152, v160, v161
    v_exp_f32_e64 v163, v163
    v_mfma_f32_32x32x16_bf16 v[80:95], a[112:115], v[144:147], v[80:95]
    ds_read_b64_tr_b16 a[100:101], v6 offset:36928
    ds_read_b64_tr_b16 a[102:103], v6 offset:40000
    v_fma_f32 v165, v133, s26, -v13
    v_add_f32 v15, v15, v162
    v_exp_f32 v164, v164
    v_mfma_f32_32x32x16_bf16 v[96:111], a[116:119], v[144:147], v[96:111]
    buffer_load_dwordx4 v12, s[12:15], s22 offen offset:2048 lds
    v_fma_f32 v166, v134, s26, -v13
    v_add_f32_e64 v15, v15, v163
    v_cvt_pk_bf16_f32 v153, v162, v163
    v_exp_f32_e64 v165, v165
    v_mfma_f32_32x32x16_bf16 v[16:31], a[120:123], v[148:151], v[16:31]
    ds_read_b64_tr_b16 a[104:105], v5 offset:36992
    ds_read_b64_tr_b16 a[106:107], v5 offset:40064
    v_fma_f32 v167, v135, s26, -v13
    v_add_f32 v15, v15, v164
    v_exp_f32 v166, v166
    v_mfma_f32_32x32x16_bf16 v[32:47], a[124:127], v[148:151], v[32:47]
    ds_read_b64_tr_b16 a[108:109], v6 offset:37056
    ds_read_b64_tr_b16 a[110:111], v6 offset:40128
    v_fma_f32 v160, v136, s26, -v13
    v_add_f32_e64 v15, v15, v165
    v_cvt_pk_bf16_f32 v154, v164, v165
    v_exp_f32_e64 v167, v167
    v_mfma_f32_32x32x16_bf16 v[48:63], a[128:131], v[148:151], v[48:63]
    ds_read_b64_tr_b16 a[120:121], v5 offset:43008
    ds_read_b64_tr_b16 a[122:123], v5 offset:46080
    v_fma_f32 v161, v137, s26, -v13
    v_add_f32 v15, v15, v166
    v_exp_f32 v160, v160
    v_mfma_f32_32x32x16_bf16 v[64:79], a[132:135], v[148:151], v[64:79]
    ds_read_b64_tr_b16 a[124:125], v6 offset:43072
    ds_read_b64_tr_b16 a[126:127], v6 offset:46144
    v_fma_f32 v162, v138, s26, -v13
    v_add_f32_e64 v15, v15, v167
    v_cvt_pk_bf16_f32 v155, v166, v167
    v_exp_f32_e64 v161, v161
    v_mfma_f32_32x32x16_bf16 v[80:95], a[136:139], v[148:151], v[80:95]
    ds_read_b64_tr_b16 a[128:129], v5 offset:43136
    s_load_dword s22, s[96:97], s30
    v_fma_f32 v163, v139, s26, -v13
    v_add_f32 v15, v15, v160
    v_exp_f32 v162, v162
    v_mfma_f32_32x32x16_bf16 v[96:111], a[140:143], v[148:151], v[96:111]
    ds_read_b64_tr_b16 a[130:131], v5 offset:46208
    v_fma_f32 v164, v140, s26, -v13
    v_add_f32_e64 v15, v15, v161
    v_cvt_pk_bf16_f32 v156, v160, v161
    v_exp_f32_e64 v163, v163
L_tailL:
    s_cmp_lg_u32 s41, 0
    s_cbranch_scc1 L_qd2
L_qdb3:
    ds_read_b64_tr_b16 a[132:133], v6 offset:43200
    ds_read_b64_tr_b16 a[134:135], v6 offset:46272
    ds_read_b64_tr_b16 a[112:113], v5 offset:37120
    ds_read_b64_tr_b16 a[114:115], v5 offset:40192
    v_fma_f32 v165, v141, s26, -v13
    v_add_f32 v15, v15, v162
    v_exp_f32 v164, v164
    v_fma_f32 v166, v142, s26, -v13
    v_add_f32_e64 v15, v15, v163
    v_cvt_pk_bf16_f32 v157, v162, v163
    v_exp_f32_e64 v165, v165
    v_fma_f32 v167, v143, s26, -v13
    v_add_f32 v15, v15, v164
    v_exp_f32 v166, v166
    v_exp_f32 v167, v167
    v_add_f32 v15, v15, v165
    v_cvt_pk_bf16_f32 v158, v164, v165
    v_add_f32 v15, v15, v166
    v_add_f32 v15, v15, v167
    v_cvt_pk_bf16_f32 v159, v166, v167
L_t1B:
    v_cmp_lt_f32_e64 vcc, s27, v15
    s_cbranch_vccnz L_rareB
L_backB:
    s_waitcnt lgkmcnt(6)
    v_mfma_f32_32x32x16_bf16 v[16:31], a[96:99], v[152:155], v[16:31]
    ds_read_b64_tr_b16 a[136:137], v5 offset:43264
    ds_read_b64_tr_b16 a[138:139], v5 offset:46336
    v_add_f32 v14, v14, v15
    v_mov_b32 v168, v14
    v_mfma_f32_32x32x16_bf16 v[16:31], a[120:123], v[156:159], v[16:31]
    ds_read_b64_tr_b16 a[116:117], v6 offset:37184
    ds_read_b64_tr_b16 a[118:119], v6 offset:40256
    v_permlane32_swap_b32 v14, v168
    v_add_f32 v14, v14, v168
    v_rcp_f32_e64 v248, v14
    v_mfma_f32_32x32x16_bf16 v[32:47], a[100:103], v[152:155], v[32:47]
    ds_read_b64_tr_b16 a[140:141], v6 offset:43328
    ds_read_b64_tr_b16 a[142:143], v6 offset:46400
    s_nop 1
    v_mov_b32 v249, v248
    v_mfma_f32_32x32x16_bf16 v[32:47], a[124:127], v[156:159], v[32:47]
    v_mul_f32 v16, v16, v248
    v_mul_f32 v17, v17, v248
    v_mul_f32 v18, v18, v248
    v_mul_f32 v19, v19, v248
    v_cvt_pk_bf16_f32 v16, v16, v17
    v_cvt_pk_bf16_f32 v17, v18, v19
    v_mul_f32_e64 v20, v20, v248
    v_mfma_f32_32x32x16_bf16 v[48:63], a[104:107], v[152:155], v[48:63]
    v_mul_f32_e64 v21, v21, v248
    v_mul_f32 v22, v22, v248
    v_mul_f32 v23, v23, v248
    v_cvt_pk_bf16_f32 v18, v20, v21
    v_cvt_pk_bf16_f32 v19, v22, v23
    v_mul_f32_e64 v24, v24, v248
    v_mul_f32 v25, v25, v248
    s_waitcnt lgkmcnt(10)
    v_mfma_f32_32x32x16_bf16 v[48:63], a[128:131], v[156:159], v[48:63]
    ds_write_b128 v230, v[16:19]
    v_mul_f32 v26, v26, v248
    v_mul_f32 v27, v27, v248
    v_mfma_f32_32x32x16_bf16 v[64:79], a[108:111], v[152:155], v[64:79]
    v_cvt_pk_bf16_f32 v24, v24, v25
    v_cvt_pk_bf16_f32 v25, v26, v27
    v_mul_f32 v28, v28, v248
    v_mul_f32 v29, v29, v248
    v_mul_f32 v30, v30, v248
    v_mul_f32 v31, v31, v248
    v_cvt_pk_bf16_f32 v26, v28, v29
    s_waitcnt lgkmcnt(7)
    v_mfma_f32_32x32x16_bf16 v[64:79], a[132:135], v[156:159], v[64:79]
    v_cvt_pk_bf16_f32 v27, v30, v31
    v_mul_f32 v32, v32, v248
    v_mul_f32_e64 v33, v33, v248
    v_mul_f32 v34, v34, v248
    v_mul_f32 v35, v35, v248
    v_cvt_pk_bf16_f32 v32, v32, v33
    v_cvt_pk_bf16_f32 v33, v34, v35
    v_mfma_f32_32x32x16_bf16 v[80:95], a[112:115], v[152:155], v[80:95]
    ds_write_b128 v231, v[24:27]
    v_mul_f32_e64 v36, v36, v248
    v_mul_f32 v37, v37, v248
    s_waitcnt lgkmcnt(6)
    v_mfma_f32_32x32x16_bf16 v[80:95], a[136:139], v[156:159], v[80:95]
    v_mul_f32 v38, v38, v248
    v_mul_f32 v39, v39, v248
    v_cvt_pk_bf16_f32 v34, v36, v37
    v_cvt_pk_bf16_f32 v35, v38, v39
    v_mul_f32 v40, v40, v248
    v_mul_f32 v41, v41, v248
    v_mul_f32 v42, v42, v248
    s_waitcnt lgkmcnt(4)
    v_mfma_f32_32x32x16_bf16 v[96:111], a[116:119], v[152:155], v[96:111]
    v_mul_f32_e64 v43, v43, v248
    v_cvt_pk_bf16_f32 v40, v40, v41
    v_cvt_pk_bf16_f32 v41, v42, v43
    v_mul_f32_e64 v44, v44, v248
    v_mul_f32 v45, v45, v248
    v_mul_f32 v46, v46, v248
    v_mul_f32 v47, v47, v248
    s_waitcnt lgkmcnt(2)
    v_mfma_f32_32x32x16_bf16 v[96:111], a[140:143], v[156:159], v[96:111]
    v_cvt_pk_bf16_f32 v42, v44, v45
    v_cvt_pk_bf16_f32 v43, v46, v47
L_rest:
    ds_write_b128 v232, v[32:35]
    ds_write_b128 v233, v[40:43]
    ds_read_b128 a[144:147], v238 offset:0
    ds_read_b128 a[148:151], v238 offset:1024
    ds_read_b128 a[152:155], v238 offset:2048
    ds_read_b128 a[156:159], v238 offset:3072
    v_pk_mul_f32 v[48:49], v[48:49], v[248:249]
    v_pk_mul_f32 v[50:51], v[50:51], v[248:249]
    v_pk_mul_f32 v[52:53], v[52:53], v[248:249]
    v_pk_mul_f32 v[54:55], v[54:55], v[248:249]
    v_pk_mul_f32 v[56:57], v[56:57], v[248:249]
    v_pk_mul_f32 v[58:59], v[58:59], v[248:249]
    v_pk_mul_f32 v[60:61], v[60:61], v[248:249]
    v_pk_mul_f32 v[62:63], v[62:63], v[248:249]
    v_cvt_pk_bf16_f32 v48, v48, v49
    v_cvt_pk_bf16_f32 v49, v50, v51
    v_cvt_pk_bf16_f32 v50, v52, v53
    v_cvt_pk_bf16_f32 v51, v54, v55
    v_cvt_pk_bf16_f32 v56, v56, v57
    v_cvt_pk_bf16_f32 v57, v58, v59
    v_cvt_pk_bf16_f32 v58, v60, v61
    v_cvt_pk_bf16_f32 v59, v62, v63
    ds_write_b128 v230, v[48:51]
    ds_write_b128 v231, v[56:59]
    s_waitcnt lgkmcnt(5)
    buffer_store_dwordx4 a[144:147], v239, s[16:19], s80 offen offset:0 sc1
    s_waitcnt lgkmcnt(4)
    buffer_store_dwordx4 a[148:151], v239, s[16:19], s81 offen offset:0 sc1
    s_waitcnt lgkmcnt(3)
    buffer_store_dwordx4 a[152:155], v239, s[16:19], s82 offen offset:0 sc1
    s_waitcnt lgkmcnt(2)
    buffer_store_dwordx4 a[156:159], v239, s[16:19], s83 offen offset:0 sc1
    v_pk_mul_f32 v[64:65], v[64:65], v[248:249]
    v_pk_mul_f32 v[66:67], v[66:67], v[248:249]
    v_pk_mul_f32 v[68:69], v[68:69], v[248:249]
    v_pk_mul_f32 v[70:71], v[70:71], v[248:249]
    v_pk_mul_f32 v[72:73], v[72:73], v[248:249]
    v_pk_mul_f32 v[74:75], v[74:75], v[248:249]
    v_pk_mul_f32 v[76:77], v[76:77], v[248:249]
    v_pk_mul_f32 v[78:79], v[78:79], v[248:249]
    v_cvt_pk_bf16_f32 v64, v64, v65
    v_cvt_pk_bf16_f32 v65, v66, v67
    v_cvt_pk_bf16_f32 v66, v68, v69
    v_cvt_pk_bf16_f32 v67, v70, v71
    v_cvt_pk_bf16_f32 v72, v72, v73
    v_cvt_pk_bf16_f32 v73, v74, v75
    v_cvt_pk_bf16_f32 v74, v76, v77
    v_cvt_pk_bf16_f32 v75, v78, v79
    ds_write_b128 v232, v[64:67]
    ds_write_b128 v233, v[72:75]
    ds_read_b128 a[160:163], v238 offset:0
    ds_read_b128 a[164:167], v238 offset:1024
    ds_read_b128 a[168:171], v238 offset:2048
    ds_read_b128 a[172:175], v238 offset:3072
    v_pk_mul_f32 v[80:81], v[80:81], v[248:249]
    v_pk_mul_f32 v[82:83], v[82:83], v[248:249]
    v_pk_mul_f32 v[84:85], v[84:85], v[248:249]
    v_pk_mul_f32 v[86:87], v[86:87], v[248:249]
    v_pk_mul_f32 v[88:89], v[88:89], v[248:249]
    v_pk_mul_f32 v[90:91], v[90:91], v[248:249]
    v_pk_mul_f32 v[92:93], v[92:93], v[248:249]
    v_pk_mul_f32 v[94:95], v[94:95], v[248:249]
    v_cvt_pk_bf16_f32 v80, v80, v81
    v_cvt_pk_bf16_f32 v81, v82, v83
    v_cvt_pk_bf16_f32 v82, v84, v85
    v_cvt_pk_bf16_f32 v83, v86, v87
    v_cvt_pk_bf16_f32 v88, v88, v89
    v_cvt_pk_bf16_f32 v89, v90, v91
    v_cvt_pk_bf16_f32 v90, v92, v93
    v_cvt_pk_bf16_f32 v91, v94, v95
    ds_write_b128 v230, v[80:83]
    ds_write_b128 v231, v[88:91]
    s_waitcnt lgkmcnt(5)
    buffer_store_dwordx4 a[160:163], v239, s[16:19], s80 offen offset:128 sc1
    s_waitcnt lgkmcnt(4)
    buffer_store_dwordx4 a[164:167], v239, s[16:19], s81 offen offset:128 sc1
    s_waitcnt lgkmcnt(3)
    buffer_store_dwordx4 a[168:171], v239, s[16:19], s82 offen offset:128 sc1
    s_waitcnt lgkmcnt(2)
    buffer_store_dwordx4 a[172:175], v239, s[16:19], s83 offen offset:128 sc1
    v_pk_mul_f32 v[96:97], v[96:97], v[248:249]
    v_pk_mul_f32 v[98:99], v[98:99], v[248:249]
    v_pk_mul_f32 v[100:101], v[100:101], v[248:249]
    v_pk_mul_f32 v[102:103], v[102:103], v[248:249]
    v_pk_mul_f32 v[104:105], v[104:105], v[248:249]
    v_pk_mul_f32 v[106:107], v[106:107], v[248:249]
    v_pk_mul_f32 v[108:109], v[108:109], v[248:249]
    v_pk_mul_f32 v[110:111], v[110:111], v[248:249]
    v_cvt_pk_bf16_f32 v96, v96, v97
    v_cvt_pk_bf16_f32 v97, v98, v99
    v_cvt_pk_bf16_f32 v98, v100, v101
    v_cvt_pk_bf16_f32 v99, v102, v103
    v_cvt_pk_bf16_f32 v104, v104, v105
    v_cvt_pk_bf16_f32 v105, v106, v107
    v_cvt_pk_bf16_f32 v106, v108, v109
    v_cvt_pk_bf16_f32 v107, v110, v111
    ds_write_b128 v232, v[96:99]
    ds_write_b128 v233, v[104:107]
    ds_read_b128 a[176:179], v238 offset:0
    ds_read_b128 a[180:183], v238 offset:1024
    ds_read_b128 a[184:187], v238 offset:2048
    ds_read_b128 a[188:191], v238 offset:3072
    s_waitcnt lgkmcnt(3)
    buffer_store_dwordx4 a[176:179], v239, s[16:19], s80 offen offset:256 sc1
    s_waitcnt lgkmcnt(2)
    buffer_store_dwordx4 a[180:183], v239, s[16:19], s81 offen offset:256 sc1
    s_waitcnt lgkmcnt(1)
    buffer_store_dwordx4 a[184:187], v239, s[16:19], s82 offen offset:256 sc1
    s_waitcnt lgkmcnt(0)
    buffer_store_dwordx4 a[188:191], v239, s[16:19], s83 offen offset:256 sc1
    s_cmp_eq_u32 s34, 0
    s_cbranch_scc1 L_done
    s_waitcnt vmcnt(12)
L_shift:
    s_mov_b32 s32, s34
    s_mov_b32 s33, s35
    s_mov_b32 s34, 0
    s_and_b32 s88, s32, 31
    s_lshl_b32 s43, s21, 1
    s_cmp_eq_u32 s88, 2
    s_addc_u32 s43, s43, 0
    s_add_u32 s88, s88, s21
    s_lshl2_add_u32 s25, s88, s30
    s_and_b32 s80, s32, 0xffffff80
    s_add_u32 s80, s80, s29
    s_add_u32 s81, s80, 49152
    s_add_u32 s82, s80, 98304
    s_add_u32 s83, s80, 147456
    s_mov_b32 s18, s33
    s_sub_u32 s40, s25, 4
    s_mov_b32 s42, s40
    s_lshr_b32 s88, s32, 5
    s_and_b32 s88, s88, s21
    s_cbranch_scc1 L_feed2
    s_nop 0
    ds_read_b128 a[48:51], v1 offset:0
    ds_read_b128 a[0:3], v242 offset:0
    ds_read_b128 a[52:55], v2 offset:0
    ds_read_b128 a[4:7], v243 offset:0
    ds_read_b128 a[56:59], v3 offset:0
    ds_read_b128 a[8:11], v244 offset:0
    v_xor_b32 v5, 65536, v5
    v_xor_b32 v6, 65536, v6
    s_waitcnt lgkmcnt(4)
    v_mfma_f32_32x32x16_bf16 v[112:127], a[48:51], a[0:3], 0
    ds_read_b128 a[60:63], v4 offset:0
    ds_read_b128 a[12:15], v245 offset:0
    ds_read_b128 a[64:67], v1 offset:128
    s_waitcnt lgkmcnt(5)
    v_mfma_f32_32x32x16_bf16 v[112:127], a[52:55], a[4:7], v[112:127]
    ds_read_b128 a[68:71], v2 offset:128
    ds_read_b128 a[16:19], v242 offset:128
    ds_read_b128 a[72:75], v3 offset:128
    s_waitcnt lgkmcnt(6)
    v_mfma_f32_32x32x16_bf16 v[112:127], a[56:59], a[8:11], v[112:127]
    ds_read_b128 a[76:79], v4 offset:128
    ds_read_b128 a[20:23], v243 offset:128
    ds_read_b128 a[80:83], v1 offset:256
    s_waitcnt lgkmcnt(7)
    v_mfma_f32_32x32x16_bf16 v[112:127], a[60:63], a[12:15], v[112:127]
    ds_read_b128 a[84:87], v2 offset:256
    ds_read_b128 a[24:27], v244 offset:128
    ds_read_b128 a[88:91], v3 offset:256
    s_waitcnt lgkmcnt(7)
    v_mfma_f32_32x32x16_bf16 v[112:127], a[64:67], a[16:19], v[112:127]
    ds_read_b128 a[92:95], v4 offset:256
    ds_read_b128 a[28:31], v245 offset:128
    ds_read_b128 a[32:35], v242 offset:256
    s_waitcnt lgkmcnt(7)
    v_mfma_f32_32x32x16_bf16 v[112:127], a[68:71], a[20:23], v[112:127]
    ds_read_b128 a[36:39], v243 offset:256
    ds_read_b128 a[40:43], v244 offset:256
    ds_read_b128 a[44:47], v245 offset:256
    s_waitcnt lgkmcnt(7)
    v_mfma_f32_32x32x16_bf16 v[112:127], a[72:75], a[24:27], v[112:127]
    s_waitcnt lgkmcnt(5)
    s_barrier
    ds_read_b128 a[48:51], v1 offset:12288
    ds_read_b128 a[52:55], v2 offset:12288
    s_waitcnt lgkmcnt(2)
    v_mfma_f32_32x32x16_bf16 v[112:127], a[76:79], a[28:31], v[112:127]
    ds_read_b128 a[56:59], v3 offset:12288
    ds_read_b128 a[60:63], v4 offset:12288
    ds_read_b64_tr_b16 a[96:97], v5 offset:24576
    v_mfma_f32_32x32x16_bf16 v[112:127], a[80:83], a[32:35], v[112:127]
    ds_read_b128 a[64:67], v1 offset:12416
    ds_read_b128 a[68:71], v2 offset:12416
    ds_read_b64_tr_b16 a[98:99], v5 offset:27648
    v_mfma_f32_32x32x16_bf16 v[112:127], a[84:87], a[36:39], v[112:127]
    ds_read_b128 a[72:75], v3 offset:12416
    ds_read_b128 a[76:79], v4 offset:12416
    ds_read_b64_tr_b16 a[100:101], v6 offset:24640
    v_mfma_f32_32x32x16_bf16 v[112:127], a[88:91], a[40:43], v[112:127]
    ds_read_b128 a[80:83], v1 offset:12544
    ds_read_b128 a[84:87], v2 offset:12544
    ds_read_b64_tr_b16 a[102:103], v6 offset:27712
    v_mfma_f32_32x32x16_bf16 v[112:127], a[92:95], a[44:47], v[112:127]
    ds_read_b128 a[88:91], v3 offset:12544
    ds_read_b128 a[92:95], v4 offset:12544
    ds_read_b64_tr_b16 a[104:105], v5 offset:24704
    s_waitcnt lgkmcnt(10)
    s_nop 0
    v_mfma_f32_32x32x16_bf16 v[128:143], a[48:51], a[0:3], 0
    ds_read_b64_tr_b16 a[106:107], v5 offset:27776
    ds_read_b64_tr_b16 a[108:109], v6 offset:24768
    ds_read_b64_tr_b16 a[110:111], v6 offset:27840
    ds_read_b64_tr_b16 a[112:113], v5 offset:24832
    ds_read_b64_tr_b16 a[114:115], v5 offset:27904
    v_mfma_f32_32x32x16_bf16 v[128:143], a[52:55], a[4:7], v[128:143]
    s_add_u32 m0, s24, 12288
    ds_read_b64_tr_b16 a[116:117], v6 offset:24896
    s_nop 1
    s_cmp_eq_u32 s43, 1
    s_cbranch_scc1 L_maskP2
    s_nop 0
L_maskbP2:
    v_max3_f32 v168, v112, v113, v114
    v_max3_f32 v169, v115, v116, v117
    v_max3_f32 v168, v168, v118, v119
    v_max3_f32 v169, v169, v120, v121
    v_max3_f32 v168, v168, v122, v123
    v_max3_f32 v169, v169, v124, v125
    v_max3_f32 v168, v168, v126, v127
    v_max_f32_e64 v168, v168, v169
    v_mfma_f32_32x32x16_bf16 v[128:143], a[56:59], a[8:11], v[128:143]
    buffer_load_dwordx4 v7, s[8:11], s23 offen offset:0 lds
    ds_read_b64_tr_b16 a[118:119], v6 offset:27968
    ds_read_b64_tr_b16 a[120:121], v5 offset:30720
    v_mov_b32_e64 v169, v168
    s_nop 1
    v_permlane32_swap_b32 v168, v169
    v_max_f32 v168, v168, v169
    v_mul_f32 v13, s26, v168
    v_fma_f32 v160, v112, s26, -v13
    v_fma_f32 v161, v113, s26, -v13
    v_exp_f32_e64 v160, v160
    v_fma_f32 v162, v114, s26, -v13
    v_mfma_f32_32x32x16_bf16 v[128:143], a[60:63], a[12:15], v[128:143]
    buffer_load_dwordx4 v8, s[8:11], s23 offen offset:1024 lds
    ds_read_b64_tr_b16 a[122:123], v5 offset:33792
    ds_read_b64_tr_b16 a[124:125], v6 offset:30784
    v_exp_f32_e64 v161, v161
    v_fma_f32 v163, v115, s26, -v13
    v_exp_f32_e64 v162, v162
    v_fma_f32 v164, v116, s26, -v13
    v_add_f32_e64 v15, v160, v161
    v_cvt_pk_bf16_f32 v144, v160, v161
    v_mfma_f32_32x32x16_bf16 v[128:143], a[64:67], a[16:19], v[128:143]
    buffer_load_dwordx4 v9, s[8:11], s23 offen offset:2048 lds
    ds_read_b64_tr_b16 a[126:127], v6 offset:33856
    v_exp_f32_e64 v163, v163
    v_fma_f32 v165, v117, s26, -v13
    v_add_f32 v15, v15, v162
    v_exp_f32 v164, v164
    v_fma_f32 v166, v118, s26, -v13
    v_add_f32_e64 v15, v15, v163
    v_mfma_f32_32x32x16_bf16 v[128:143], a[68:71], a[20:23], v[128:143]
    s_add_u32 m0, s24, 36864
    ds_read_b64_tr_b16 a[128:129], v5 offset:30848
    ds_read_b64_tr_b16 a[130:131], v5 offset:33920
    v_cvt_pk_bf16_f32 v145, v162, v163
    v_exp_f32_e64 v165, v165
    v_fma_f32 v167, v119, s26, -v13
    v_add_f32 v15, v15, v164
    v_exp_f32 v166, v166
    v_fma_f32 v160, v120, s26, -v13
    s_waitcnt lgkmcnt(14)
    v_mfma_f32_32x32x16_bf16 v[128:143], a[72:75], a[24:27], v[128:143]
    buffer_load_dwordx4 v10, s[12:15], s23 offen offset:0 lds
    ds_read_b64_tr_b16 a[132:133], v6 offset:30912
    v_add_f32 v15, v15, v165
    v_cvt_pk_bf16_f32 v146, v164, v165
    v_exp_f32_e64 v167, v167
    v_fma_f32 v161, v121, s26, -v13
    v_add_f32 v15, v15, v166
    v_exp_f32 v160, v160
    v_mfma_f32_32x32x16_bf16 v[128:143], a[76:79], a[28:31], v[128:143]
    buffer_load_dwordx4 v11, s[12:15], s23 offen offset:1024 lds
    ds_read_b64_tr_b16 a[134:135], v6 offset:33984
    ds_read_b64_tr_b16 a[136:137], v5 offset:30976
    v_fma_f32 v162, v122, s26, -v13
    v_add_f32_e64 v15, v15, v167
    v_cvt_pk_bf16_f32 v147, v166, v167
    v_exp_f32_e64 v161, v161
    v_fma_f32 v163, v123, s26, -v13
    v_add_f32_e64 v15, v15, v160
    v_mfma_f32_32x32x16_bf16 v[128:143], a[80:83], a[32:35], v[128:143]
    buffer_load_dwordx4 v12, s[12:15], s23 offen offset:2048 lds
    s_xor_b32 s24, s24, 65536
    ds_read_b64_tr_b16 a[138:139], v5 offset:34048
    v_exp_f32_e64 v162, v162
    v_fma_f32 v164, v124, s26, -v13
    v_add_f32_e64 v15, v15, v161
    v_cvt_pk_bf16_f32 v148, v160, v161
    v_exp_f32_e64 v163, v163
    v_fma_f32 v165, v125, s26, -v13
    v_mfma_f32_32x32x16_bf16 v[128:143], a[84:87], a[36:39], v[128:143]
    s_and_b32 m0, s24, 0xfffff
    s_load_dword s23, s[96:97], s30 offset:4
    buffer_load_dwordx4 v7, s[8:11], s22 offen offset:0 lds
    ds_read_b64_tr_b16 a[140:141], v6 offset:31040
    v_add_f32 v15, v15, v162
    v_exp_f32 v164, v164
    v_fma_f32 v166, v126, s26, -v13
    v_add_f32_e64 v15, v15, v163
    v_cvt_pk_bf16_f32 v149, v162, v163
    v_exp_f32_e64 v165, v165
    v_mfma_f32_32x32x16_bf16 v[128:143], a[88:91], a[40:43], v[128:143]
    buffer_load_dwordx4 v8, s[8:11], s22 offen offset:1024 lds
    s_add_u32 s30, s30, 8
    ds_read_b64_tr_b16 a[142:143], v6 offset:34112
    v_fma_f32 v167, v127, s26, -v13
    v_add_f32 v15, v15, v164
    v_exp_f32_e64 v166, v166
    v_exp_f32 v167, v167
    v_add_f32 v15, v15, v165
    v_cvt_pk_bf16_f32 v150, v164, v165
    v_mfma_f32_32x32x16_bf16 v[128:143], a[92:95], a[44:47], v[128:143]
    buffer_load_dwordx4 v9, s[8:11], s22 offen offset:2048 lds
    v_add_f32 v15, v15, v166
    v_add_f32 v15, v15, v167
    v_cvt_pk_bf16_f32 v151, v166, v167
    v_xor_b32 v1, 65536, v1
    v_xor_b32 v2, 65536, v2
    v_xor_b32 v3, 65536, v3
    v_xor_b32 v4, 65536, v4
    v_mov_b32 v14, v15
    s_waitcnt lgkmcnt(0)
    s_bitcmp0_b32 s43, 0
    s_cbranch_scc1 L_first
    s_cmp_eq_u32 s43, 1
    s_cbranch_scc1 L_one
    s_waitcnt lgkmcnt(0)
    s_barrier
    v_mfma_f32_32x32x16_bf16 v[16:31], a[96:99], v[144:147], 0
    s_add_u32 m0, s24, 24576
    s_nop 1
    s_nop 0
    v_mfma_f32_32x32x16_bf16 v[32:47], a[100:103], v[144:147], 0
    buffer_load_dwordx4 v10, s[12:15], s22 offen offset:0 lds
    v_cndmask_b32 v128, v128, v241, s[48:49]
    v_cndmask_b32 v129, v129, v241, s[50:51]
    v_fma_f32 v160, v128, s26, -v13
    v_cndmask_b32 v130, v130, v241, s[52:53]
    v_fma_f32 v161, v129, s26, -v13
    v_cndmask_b32 v131, v131, v241, s[54:55]
    v_exp_f32_e64 v160, v160
    v_mfma_f32_32x32x16_bf16 v[48:63], a[104:107], v[144:147], 0
    ds_read_b64_tr_b16 a[96:97], v5 offset:36864
    ds_read_b64_tr_b16 a[98:99], v5 offset:39936
    v_fma_f32 v162, v130, s26, -v13
    v_cndmask_b32 v132, v132, v241, s[56:57]
    v_exp_f32_e64 v161, v161
    v_fma_f32 v163, v131, s26, -v13
    v_cndmask_b32 v133, v133, v241, s[58:59]
    v_exp_f32_e64 v162, v162
    v_fma_f32 v164, v132, s26, -v13
    v_mfma_f32_32x32x16_bf16 v[64:79], a[108:111], v[144:147], 0
    buffer_load_dwordx4 v11, s[12:15], s22 offen offset:1024 lds
    v_cndmask_b32 v134, v134, v241, s[60:61]
    v_add_f32_e64 v15, v160, v161
    v_cvt_pk_bf16_f32 v152, v160, v161
    v_exp_f32_e64 v163, v163
    v_mfma_f32_32x32x16_bf16 v[80:95], a[112:115], v[144:147], 0
    ds_read_b64_tr_b16 a[100:101], v6 offset:36928
    ds_read_b64_tr_b16 a[102:103], v6 offset:40000
    v_fma_f32 v165, v133, s26, -v13
    v_cndmask_b32 v135, v135, v241, s[62:63]
    v_add_f32 v15, v15, v162
    v_exp_f32 v164, v164
    v_mfma_f32_32x32x16_bf16 v[96:111], a[116:119], v[144:147], 0
    buffer_load_dwordx4 v12, s[12:15], s22 offen offset:2048 lds
    v_fma_f32 v166, v134, s26, -v13
    v_cndmask_b32 v136, v136, v241, s[64:65]
    v_add_f32_e64 v15, v15, v163
    v_cvt_pk_bf16_f32 v153, v162, v163
    v_exp_f32_e64 v165, v165
    v_mfma_f32_32x32x16_bf16 v[16:31], a[120:123], v[148:151], v[16:31]
    ds_read_b64_tr_b16 a[104:105], v5 offset:36992
    ds_read_b64_tr_b16 a[106:107], v5 offset:40064
    v_fma_f32 v167, v135, s26, -v13
    v_cndmask_b32 v137, v137, v241, s[66:67]
    v_add_f32 v15, v15, v164
    v_exp_f32 v166, v166
    v_mfma_f32_32x32x16_bf16 v[32:47], a[124:127], v[148:151], v[32:47]
    ds_read_b64_tr_b16 a[108:109], v6 offset:37056
    ds_read_b64_tr_b16 a[110:111], v6 offset:40128
    v_fma_f32 v160, v136, s26, -v13
    v_cndmask_b32 v138, v138, v241, s[68:69]
    v_add_f32_e64 v15, v15, v165
    v_cvt_pk_bf16_f32 v154, v164, v165
    v_exp_f32_e64 v167, v167
    v_mfma_f32_32x32x16_bf16 v[48:63], a[128:131], v[148:151], v[48:63]
    ds_read_b64_tr_b16 a[120:121], v5 offset:43008
    ds_read_b64_tr_b16 a[122:123], v5 offset:46080
    v_fma_f32 v161, v137, s26, -v13
    v_cndmask_b32 v139, v139, v241, s[70:71]
    v_add_f32 v15, v15, v166
    v_exp_f32 v160, v160
    v_mfma_f32_32x32x16_bf16 v[64:79], a[132:135], v[148:151], v[64:79]
    ds_read_b64_tr_b16 a[124:125], v6 offset:43072
    ds_read_b64_tr_b16 a[126:127], v6 offset:46144
    v_fma_f32 v162, v138, s26, -v13
    v_cndmask_b32 v140, v140, v241, s[72:73]
    v_add_f32_e64 v15, v15, v167
    v_cvt_pk_bf16_f32 v155, v166, v167
    v_exp_f32_e64 v161, v161
    v_mfma_f32_32x32x16_bf16 v[80:95], a[136:139], v[148:151], v[80:95]
    ds_read_b64_tr_b16 a[128:129], v5 offset:43136
    s_load_dword s22, s[96:97], s30
    v_fma_f32 v163, v139, s26, -v13
    v_cndmask_b32 v141, v141, v241, s[74:75]
    v_add_f32 v15, v15, v160
    v_exp_f32 v162, v162
    v_mfma_f32_32x32x16_bf16 v[96:111], a[140:143], v[148:151], v[96:111]
    ds_read_b64_tr_b16 a[130:131], v5 offset:46208
    v_fma_f32 v164, v140, s26, -v13
    v_cndmask_b32 v142, v142, v241, s[76:77]
    v_add_f32_e64 v15, v15, v161
    v_cvt_pk_bf16_f32 v156, v160, v161
    v_exp_f32_e64 v163, v163
    v_cndmask_b32 v143, v143, v241, s[78:79]
    s_branch L_tailL
L_done:
L_end:
    s_endpgm
L_warm1:
    s_branch L_warmb
L_tailA:
    s_cmp_lg_u32 s41, 0
    s_cbranch_scc1 L_qd5
L_qdb6:
    s_add_u32 m0, s24, 0
    ds_read_b64_tr_b16 a[112:113], v5 offset:24832
    ds_read_b64_tr_b16 a[114:115], v5 offset:27904
    ds_read_b64_tr_b16 a[116:117], v6 offset:24896
    ds_read_b64_tr_b16 a[118:119], v6 offset:27968
    buffer_load_dwordx4 v7, s[8:11], s22 offen offset:0 lds
    ds_read_b64_tr_b16 a[120:121], v5 offset:30720
    ds_read_b64_tr_b16 a[122:123], v5 offset:33792
    ds_read_b64_tr_b16 a[124:125], v6 offset:30784
    ds_read_b64_tr_b16 a[126:127], v6 offset:33856
    buffer_load_dwordx4 v8, s[8:11], s22 offen offset:1024 lds
    ds_read_b64_tr_b16 a[128:129], v5 offset:30848
    ds_read_b64_tr_b16 a[130:131], v5 offset:33920
    ds_read_b64_tr_b16 a[132:133], v6 offset:30912
    ds_read_b64_tr_b16 a[134:135], v6 offset:33984
    buffer_load_dwordx4 v9, s[8:11], s22 offen offset:2048 lds
    ds_read_b64_tr_b16 a[136:137], v5 offset:30976
    ds_read_b64_tr_b16 a[138:139], v5 offset:34048
    ds_read_b64_tr_b16 a[140:141], v6 offset:31040
    ds_read_b64_tr_b16 a[142:143], v6 offset:34112
    v_fma_f32 v162, v122, s26, -v13
    v_add_f32_e64 v15, v15, v167
    v_cvt_pk_bf16_f32 v147, v166, v167
    v_exp_f32_e64 v161, v161
    v_fma_f32 v163, v123, s26, -v13
    v_add_f32 v15, v15, v160
    v_exp_f32 v162, v162
    v_fma_f32 v164, v124, s26, -v13
    v_add_f32_e64 v15, v15, v161
    v_cvt_pk_bf16_f32 v148, v160, v161
    v_exp_f32_e64 v163, v163
    v_fma_f32 v165, v125, s26, -v13
    v_add_f32 v15, v15, v162
    v_exp_f32 v164, v164
    v_fma_f32 v166, v126, s26, -v13
    v_add_f32_e64 v15, v15, v163
    v_cvt_pk_bf16_f32 v149, v162, v163
    v_exp_f32_e64 v165, v165
    s_waitcnt vmcnt(12) lgkmcnt(0)
    s_barrier
    v_fma_f32 v167, v127, s26, -v13
    v_add_f32 v15, v15, v164
    v_exp_f32 v166, v166
    v_exp_f32 v167, v167
    v_add_f32 v15, v15, v165
    v_cvt_pk_bf16_f32 v150, v164, v165
    v_add_f32 v15, v15, v166
    v_add_f32 v15, v15, v167
    v_cvt_pk_bf16_f32 v151, v166, v167
    v_cmp_lt_f32 vcc, s27, v15
    s_cbranch_vccnz L_rareA
L_backA:
    v_mfma_f32_32x32x16_bf16 v[16:31], a[96:99], v[144:147], v[16:31]
    s_add_u32 m0, s24, 24576
    v_add_f32 v14, v14, v15
    v_mov_b32 v168, v14
    v_mfma_f32_32x32x16_bf16 v[16:31], a[120:123], v[148:151], v[16:31]
    buffer_load_dwordx4 v10, s[12:15], s22 offen offset:0 lds
    buffer_load_dwordx4 v11, s[12:15], s22 offen offset:1024 lds
    buffer_load_dwordx4 v12, s[12:15], s22 offen offset:2048 lds
    v_permlane32_swap_b32 v14, v168
    v_add_f32 v14, v14, v168
    v_rcp_f32_e64 v248, v14
    v_mfma_f32_32x32x16_bf16 v[32:47], a[100:103], v[144:147], v[32:47]
    s_load_dword s22, s[96:97], s30
    s_nop 0
    v_xor_b32 v1, 65536, v1
    v_xor_b32 v2, 65536, v2
    v_xor_b32 v3, 65536, v3
    v_xor_b32 v4, 65536, v4
    v_mov_b32 v249, v248
    v_mfma_f32_32x32x16_bf16 v[32:47], a[124:127], v[148:151], v[32:47]
    v_mul_f32 v16, v16, v248
    v_mul_f32 v17, v17, v248
    v_mul_f32 v18, v18, v248
    v_mul_f32 v19, v19, v248
    v_cvt_pk_bf16_f32 v16, v16, v17
    v_cvt_pk_bf16_f32 v17, v18, v19
    v_mul_f32_e64 v20, v20, v248
    v_mfma_f32_32x32x16_bf16 v[48:63], a[104:107], v[144:147], v[48:63]
    v_mul_f32_e64 v21, v21, v248
    v_mul_f32 v22, v22, v248
    v_mul_f32 v23, v23, v248
    v_cvt_pk_bf16_f32 v18, v20, v21
    v_cvt_pk_bf16_f32 v19, v22, v23
    v_mul_f32 v24, v24, v248
    v_mul_f32 v25, v25, v248
    v_mfma_f32_32x32x16_bf16 v[48:63], a[128:131], v[148:151], v[48:63]
    ds_write_b128 v230, v[16:19]
    v_mul_f32 v26, v26, v248
    v_mul_f32 v27, v27, v248
    v_mfma_f32_32x32x16_bf16 v[64:79], a[108:111], v[144:147], v[64:79]
    v_cvt_pk_bf16_f32 v24, v24, v25
    v_cvt_pk_bf16_f32 v25, v26, v27
    v_mul_f32 v28, v28, v248
    v_mul_f32 v29, v29, v248
    v_mul_f32 v30, v30, v248
    v_mul_f32 v31, v31, v248
    v_cvt_pk_bf16_f32 v26, v28, v29
    v_mfma_f32_32x32x16_bf16 v[64:79], a[132:135], v[148:151], v[64:79]
    v_cvt_pk_bf16_f32 v27, v30, v31
    v_mul_f32 v32, v32, v248
    v_mul_f32 v33, v33, v248
    v_mul_f32 v34, v34, v248
    v_mul_f32 v35, v35, v248
    v_cvt_pk_bf16_f32 v32, v32, v33
    v_cvt_pk_bf16_f32 v33, v34, v35
    v_mfma_f32_32x32x16_bf16 v[80:95], a[112:115], v[144:147], v[80:95]
    ds_write_b128 v231, v[24:27]
    v_mul_f32 v36, v36, v248
    v_mul_f32 v37, v37, v248
    v_mfma_f32_32x32x16_bf16 v[80:95], a[136:139], v[148:151], v[80:95]
    v_mul_f32 v38, v38, v248
    v_mul_f32 v39, v39, v248
    v_cvt_pk_bf16_f32 v34, v36, v37
    v_cvt_pk_bf16_f32 v35, v38, v39
    v_mul_f32_e64 v40, v40, v248
    v_mul_f32 v41, v41, v248
    v_mul_f32 v42, v42, v248
    v_mfma_f32_32x32x16_bf16 v[96:111], a[116:119], v[144:147], v[96:111]
    v_mul_f32_e64 v43, v43, v248
    v_cvt_pk_bf16_f32 v40, v40, v41
    v_cvt_pk_bf16_f32 v41, v42, v43
    v_mul_f32 v44, v44, v248
    v_mul_f32 v45, v45, v248
    v_mul_f32 v46, v46, v248
    v_mul_f32 v47, v47, v248
    v_mfma_f32_32x32x16_bf16 v[96:111], a[140:143], v[148:151], v[96:111]
    v_cvt_pk_bf16_f32 v42, v44, v45
    v_cvt_pk_bf16_f32 v43, v46, v47
    s_branch L_rest
L_feed1:
    s_add_u32 m0, s24, 0
    s_nop 0
    buffer_load_dwordx4 v7, s[8:11], s22 offen offset:0 lds
    buffer_load_dwordx4 v8, s[8:11], s22 offen offset:1024 lds
    buffer_load_dwordx4 v9, s[8:11], s22 offen offset:2048 lds
    s_add_u32 m0, s24, 24576
    s_nop 0
    buffer_load_dwordx4 v10, s[12:15], s22 offen offset:0 lds
    buffer_load_dwordx4 v11, s[12:15], s22 offen offset:1024 lds
    buffer_load_dwordx4 v12, s[12:15], s22 offen offset:2048 lds
    s_load_dword s22, s[96:97], s30
L_feed2:
    s_and_b32 s25, s32, 31
    s_lshr_b32 s25, s25, 1
L_h1:
    s_add_u32 m0, s24, 12288
    s_nop 0
    buffer_load_dwordx4 v7, s[8:11], s23 offen offset:0 lds
    buffer_load_dwordx4 v8, s[8:11], s23 offen offset:1024 lds
    buffer_load_dwordx4 v9, s[8:11], s23 offen offset:2048 lds
    s_waitcnt vmcnt(12) lgkmcnt(0)
    s_barrier
    s_add_u32 m0, s24, 36864
    s_nop 0
    buffer_load_dwordx4 v10, s[12:15], s23 offen offset:0 lds
    buffer_load_dwordx4 v11, s[12:15], s23 offen offset:1024 lds
    buffer_load_dwordx4 v12, s[12:15], s23 offen offset:2048 lds
    s_load_dword s23, s[96:97], s30 offset:4
    s_add_u32 s30, s30, 8
    s_nop 0
    s_xor_b32 s24, s24, 65536
    v_xor_b32 v5, 65536, v5
    v_xor_b32 v6, 65536, v6
    v_xor_b32 v1, 65536, v1
    v_xor_b32 v2, 65536, v2
    v_xor_b32 v3, 65536, v3
    v_xor_b32 v4, 65536, v4
    s_add_u32 m0, s24, 0
    s_nop 0
    buffer_load_dwordx4 v7, s[8:11], s22 offen offset:0 lds
    buffer_load_dwordx4 v8, s[8:11], s22 offen offset:1024 lds
    buffer_load_dwordx4 v9, s[8:11], s22 offen offset:2048 lds
    s_waitcnt vmcnt(12) lgkmcnt(0)
    s_barrier
    s_add_u32 m0, s24, 24576
    s_nop 0
    buffer_load_dwordx4 v10, s[12:15], s22 offen offset:0 lds
    buffer_load_dwordx4 v11, s[12:15], s22 offen offset:1024 lds
    buffer_load_dwordx4 v12, s[12:15], s22 offen offset:2048 lds
    s_load_dword s22, s[96:97], s30
    s_cmp_eq_u32 s41, 0
    s_cbranch_scc1 L_h3
    s_sub_u32 s41, s41, 1
    s_cmp_eq_u32 s41, 0
    s_cbranch_scc1 L_qs8
    s_and_b32 s93, s34, 0xffffff80
    s_add_u32 s93, s93, s29
    s_mov_b32 s6, s35
    s_add_u32 m0, s28, 6144
    s_add_u32 s91, s93, 98304
    buffer_load_dwordx4 v224, s[4:7], s91 offen offset:0 nt lds
    buffer_load_dwordx4 v225, s[4:7], s91 offen offset:1024 nt lds
    buffer_load_dwordx4 v226, s[4:7], s91 offen offset:2048 nt lds
    s_add_u32 m0, s28, 9216
    s_add_u32 s91, s93, 147456
    buffer_load_dwordx4 v227, s[4:7], s91 offen offset:0 nt lds
    buffer_load_dwordx4 v228, s[4:7], s91 offen offset:1024 nt lds
    buffer_load_dwordx4 v229, s[4:7], s91 offen offset:2048 nt lds
    s_branch L_h3
    s_nop 0
L_qs8:
    s_and_b32 s93, s34, 0xffffff80
    s_add_u32 s93, s93, s29
    s_mov_b32 s6, s35
    s_add_u32 m0, s28, 0
    s_add_u32 s91, s93, 0
    buffer_load_dwordx4 v224, s[4:7], s91 offen offset:0 nt lds
    buffer_load_dwordx4 v225, s[4:7], s91 offen offset:1024 nt lds
    buffer_load_dwordx4 v226, s[4:7], s91 offen offset:2048 nt lds
    s_add_u32 m0, s28, 3072
    s_add_u32 s91, s93, 49152
    buffer_load_dwordx4 v227, s[4:7], s91 offen offset:0 nt lds
    buffer_load_dwordx4 v228, s[4:7], s91 offen offset:1024 nt lds
    buffer_load_dwordx4 v229, s[4:7], s91 offen offset:2048 nt lds
L_h3:
    s_sub_u32 s25, s25, 1
    s_cmp_lg_u32 s25, 0
    s_cbranch_scc1 L_h1
    s_cmp_eq_u32 s34, 0
    s_cbranch_scc1 L_done
    s_cmp_lg_u32 s41, 0
    s_cbranch_scc1 L_qd9
L_qdb10:
    s_waitcnt vmcnt(0) lgkmcnt(0)
    s_branch L_shift
.p2align 6
L_warm5:
    s_branch L_warmb
    s_nop 0
L_one:
    v_mfma_f32_32x32x16_bf16 v[16:31], a[96:99], v[144:147], 0
    s_barrier
    v_mov_b32 v168, v14
    v_mfma_f32_32x32x16_bf16 v[16:31], a[120:123], v[148:151], v[16:31]
    s_nop 0
    v_permlane32_swap_b32 v14, v168
    v_add_f32 v14, v14, v168
    v_rcp_f32 v248, v14
    v_mfma_f32_32x32x16_bf16 v[32:47], a[100:103], v[144:147], 0
    s_nop 4
    v_mov_b32 v249, v248
    v_mfma_f32_32x32x16_bf16 v[32:47], a[124:127], v[148:151], v[32:47]
    v_mul_f32 v16, v16, v248
    v_mul_f32 v17, v17, v248
    v_mul_f32 v18, v18, v248
    v_mul_f32 v19, v19, v248
    v_cvt_pk_bf16_f32 v16, v16, v17
    v_cvt_pk_bf16_f32 v17, v18, v19
    v_mul_f32_e64 v20, v20, v248
    v_mfma_f32_32x32x16_bf16 v[48:63], a[104:107], v[144:147], 0
    v_mul_f32_e64 v21, v21, v248
    v_mul_f32 v22, v22, v248
    v_mul_f32 v23, v23, v248
    v_cvt_pk_bf16_f32 v18, v20, v21
    v_cvt_pk_bf16_f32 v19, v22, v23
    v_mul_f32 v24, v24, v248
    v_mul_f32 v25, v25, v248
    v_mfma_f32_32x32x16_bf16 v[48:63], a[128:131], v[148:151], v[48:63]
    ds_write_b128 v230, v[16:19]
    v_mul_f32 v26, v26, v248
    v_mul_f32 v27, v27, v248
    v_mfma_f32_32x32x16_bf16 v[64:79], a[108:111], v[144:147], 0
    v_cvt_pk_bf16_f32 v24, v24, v25
    v_cvt_pk_bf16_f32 v25, v26, v27
    v_mul_f32 v28, v28, v248
    v_mul_f32 v29, v29, v248
    v_mul_f32 v30, v30, v248
    v_mul_f32 v31, v31, v248
    v_cvt_pk_bf16_f32 v26, v28, v29
    v_mfma_f32_32x32x16_bf16 v[64:79], a[132:135], v[148:151], v[64:79]
    v_cvt_pk_bf16_f32 v27, v30, v31
    v_mul_f32 v32, v32, v248
    v_mul_f32 v33, v33, v248
    v_mul_f32 v34, v34, v248
    v_mul_f32 v35, v35, v248
    v_cvt_pk_bf16_f32 v32, v32, v33
    v_cvt_pk_bf16_f32 v33, v34, v35
    v_mfma_f32_32x32x16_bf16 v[80:95], a[112:115], v[144:147], 0
    ds_write_b128 v231, v[24:27]
    v_mul_f32 v36, v36, v248
    v_mul_f32 v37, v37, v248
    v_mfma_f32_32x32x16_bf16 v[80:95], a[136:139], v[148:151], v[80:95]
    v_mul_f32 v38, v38, v248
    v_mul_f32 v39, v39, v248
    v_cvt_pk_bf16_f32 v34, v36, v37
    v_cvt_pk_bf16_f32 v35, v38, v39
    v_mul_f32_e64 v40, v40, v248
    v_mul_f32 v41, v41, v248
    v_mul_f32 v42, v42, v248
    v_mfma_f32_32x32x16_bf16 v[96:111], a[116:119], v[144:147], 0
    v_mul_f32_e64 v43, v43, v248
    v_cvt_pk_bf16_f32 v40, v40, v41
    v_cvt_pk_bf16_f32 v41, v42, v43
    v_mul_f32 v44, v44, v248
    v_mul_f32 v45, v45, v248
    v_mul_f32 v46, v46, v248
    v_mul_f32 v47, v47, v248
    v_mfma_f32_32x32x16_bf16 v[96:111], a[140:143], v[148:151], v[96:111]
    v_cvt_pk_bf16_f32 v42, v44, v45
    v_cvt_pk_bf16_f32 v43, v46, v47
    s_branch L_rest
L_warm2:
    s_cmp_lg_u32 s34, 0
    s_cbranch_scc1 L_warm3
    s_branch L_warmb
L_disp:
    s_cmp_eq_u32 s34, 0
    s_cbranch_scc1 L_tailA
    s_cmp_eq_u32 s41, 0
    s_cbranch_scc1 L_dispz
    s_sub_u32 s41, s41, 1
    s_cmp_eq_u32 s41, 0
    s_cbranch_scc1 L_qs1
    s_and_b32 s93, s34, 0xffffff80
    s_add_u32 s93, s93, s29
    s_mov_b32 s6, s35
    s_nop 0
    s_add_u32 m0, s28, 6144
    s_add_u32 s91, s93, 98304
    buffer_load_dwordx4 v224, s[4:7], s91 offen offset:0 nt lds
    buffer_load_dwordx4 v225, s[4:7], s91 offen offset:1024 nt lds
    buffer_load_dwordx4 v226, s[4:7], s91 offen offset:2048 nt lds
    s_add_u32 m0, s28, 9216
    s_add_u32 s91, s93, 147456
    buffer_load_dwordx4 v227, s[4:7], s91 offen offset:0 nt lds
    buffer_load_dwordx4 v228, s[4:7], s91 offen offset:1024 nt lds
    buffer_load_dwordx4 v229, s[4:7], s91 offen offset:2048 nt lds
    s_branch L_dispz
    s_nop 0
L_qs1:
    s_and_b32 s93, s34, 0xffffff80
    s_add_u32 s93, s93, s29
    s_mov_b32 s6, s35
    s_add_u32 m0, s28, 0
    s_add_u32 s91, s93, 0
    buffer_load_dwordx4 v224, s[4:7], s91 offen offset:0 nt lds
    buffer_load_dwordx4 v225, s[4:7], s91 offen offset:1024 nt lds
    buffer_load_dwordx4 v226, s[4:7], s91 offen offset:2048 nt lds
    s_add_u32 m0, s28, 3072
    s_add_u32 s91, s93, 49152
    buffer_load_dwordx4 v227, s[4:7], s91 offen offset:0 nt lds
    buffer_load_dwordx4 v228, s[4:7], s91 offen offset:1024 nt lds
    buffer_load_dwordx4 v229, s[4:7], s91 offen offset:2048 nt lds
L_dispz:
    s_add_u32 s88, s30, 4
    s_cmp_lt_u32 s88, s25
    s_cbranch_scc1 L_loop
    s_cmp_eq_u32 s30, s25
    s_cbranch_scc1 L_tailA
    s_branch L_last
L_qd2:
    s_cmp_eq_u32 s41, 1
    s_cbranch_scc1 L_qdc4
    s_and_b32 s93, s34, 0xffffff80
    s_add_u32 s93, s93, s29
    s_mov_b32 s6, s35
    s_add_u32 m0, s28, 6144
    s_add_u32 s91, s93, 98304
    buffer_load_dwordx4 v224, s[4:7], s91 offen offset:0 nt lds
    buffer_load_dwordx4 v225, s[4:7], s91 offen offset:1024 nt lds
    buffer_load_dwordx4 v226, s[4:7], s91 offen offset:2048 nt lds
    s_add_u32 m0, s28, 9216
    s_add_u32 s91, s93, 147456
    buffer_load_dwordx4 v227, s[4:7], s91 offen offset:0 nt lds
    buffer_load_dwordx4 v228, s[4:7], s91 offen offset:1024 nt lds
    buffer_load_dwordx4 v229, s[4:7], s91 offen offset:2048 nt lds
L_qdc4:
    s_and_b32 s93, s34, 0xffffff80
    s_add_u32 s93, s93, s29
    s_mov_b32 s6, s35
    s_add_u32 m0, s28, 0
    s_add_u32 s91, s93, 0
    buffer_load_dwordx4 v224, s[4:7], s91 offen offset:0 nt lds
    buffer_load_dwordx4 v225, s[4:7], s91 offen offset:1024 nt lds
    buffer_load_dwordx4 v226, s[4:7], s91 offen offset:2048 nt lds
    s_add_u32 m0, s28, 3072
    s_add_u32 s91, s93, 49152
    buffer_load_dwordx4 v227, s[4:7], s91 offen offset:0 nt lds
    buffer_load_dwordx4 v228, s[4:7], s91 offen offset:1024 nt lds
    buffer_load_dwordx4 v229, s[4:7], s91 offen offset:2048 nt lds
    s_mov_b32 s41, 0
    s_branch L_qdb3
L_warm3:
    s_branch L_warm5
    s_nop 0
L_maskP2:
    v_cndmask_b32 v112, v112, v241, s[48:49]
    v_cndmask_b32 v113, v113, v241, s[50:51]
    v_cndmask_b32 v114, v114, v241, s[52:53]
    v_cndmask_b32 v115, v115, v241, s[54:55]
    v_cndmask_b32 v116, v116, v241, s[56:57]
    v_cndmask_b32 v117, v117, v241, s[58:59]
    v_cndmask_b32 v118, v118, v241, s[60:61]
    v_cndmask_b32 v119, v119, v241, s[62:63]
    v_cndmask_b32 v120, v120, v241, s[64:65]
    v_cndmask_b32 v121, v121, v241, s[66:67]
    v_cndmask_b32 v122, v122, v241, s[68:69]
    v_cndmask_b32 v123, v123, v241, s[70:71]
    v_cndmask_b32 v124, v124, v241, s[72:73]
    v_cndmask_b32 v125, v125, v241, s[74:75]
    v_cndmask_b32 v126, v126, v241, s[76:77]
    v_cndmask_b32 v127, v127, v241, s[78:79]
    s_branch L_maskbP2
L_qd5:
    s_cmp_eq_u32 s41, 1
    s_cbranch_scc1 L_qdc7
    s_and_b32 s93, s34, 0xffffff80
    s_add_u32 s93, s93, s29
    s_mov_b32 s6, s35
    s_nop 0
    s_add_u32 m0, s28, 6144
    s_add_u32 s91, s93, 98304
    buffer_load_dwordx4 v224, s[4:7], s91 offen offset:0 nt lds
    buffer_load_dwordx4 v225, s[4:7], s91 offen offset:1024 nt lds
    buffer_load_dwordx4 v226, s[4:7], s91 offen offset:2048 nt lds
    s_add_u32 m0, s28, 9216
    s_add_u32 s91, s93, 147456
    buffer_load_dwordx4 v227, s[4:7], s91 offen offset:0 nt lds
    buffer_load_dwordx4 v228, s[4:7], s91 offen offset:1024 nt lds
    buffer_load_dwordx4 v229, s[4:7], s91 offen offset:2048 nt lds
L_qdc7:
    s_and_b32 s93, s34, 0xffffff80
    s_add_u32 s93, s93, s29
    s_mov_b32 s6, s35
    s_add_u32 m0, s28, 0
    s_add_u32 s91, s93, 0
    buffer_load_dwordx4 v224, s[4:7], s91 offen offset:0 nt lds
    buffer_load_dwordx4 v225, s[4:7], s91 offen offset:1024 nt lds
    buffer_load_dwordx4 v226, s[4:7], s91 offen offset:2048 nt lds
    s_add_u32 m0, s28, 3072
    s_add_u32 s91, s93, 49152
    buffer_load_dwordx4 v227, s[4:7], s91 offen offset:0 nt lds
    buffer_load_dwordx4 v228, s[4:7], s91 offen offset:1024 nt lds
    buffer_load_dwordx4 v229, s[4:7], s91 offen offset:2048 nt lds
    s_mov_b32 s41, 0
    s_branch L_qdb6
L_qd9:
    s_cmp_eq_u32 s41, 1
    s_cbranch_scc1 L_qdc11
    s_and_b32 s93, s34, 0xffffff80
    s_add_u32 s93, s93, s29
    s_mov_b32 s6, s35
    s_add_u32 m0, s28, 6144
    s_add_u32 s91, s93, 98304
    buffer_load_dwordx4 v224, s[4:7], s91 offen offset:0 nt lds
    buffer_load_dwordx4 v225, s[4:7], s91 offen offset:1024 nt lds
    buffer_load_dwordx4 v226, s[4:7], s91 offen offset:2048 nt lds
    s_add_u32 m0, s28, 9216
    s_add_u32 s91, s93, 147456
    buffer_load_dwordx4 v227, s[4:7], s91 offen offset:0 nt lds
    buffer_load_dwordx4 v228, s[4:7], s91 offen offset:1024 nt lds
    buffer_load_dwordx4 v229, s[4:7], s91 offen offset:2048 nt lds
L_qdc11:
    s_and_b32 s93, s34, 0xffffff80
    s_add_u32 s93, s93, s29
    s_mov_b32 s6, s35
    s_add_u32 m0, s28, 0
    s_add_u32 s91, s93, 0
    buffer_load_dwordx4 v224, s[4:7], s91 offen offset:0 nt lds
    buffer_load_dwordx4 v225, s[4:7], s91 offen offset:1024 nt lds
    buffer_load_dwordx4 v226, s[4:7], s91 offen offset:2048 nt lds
    s_add_u32 m0, s28, 3072
    s_add_u32 s91, s93, 49152
    buffer_load_dwordx4 v227, s[4:7], s91 offen offset:0 nt lds
    buffer_load_dwordx4 v228, s[4:7], s91 offen offset:1024 nt lds
    buffer_load_dwordx4 v229, s[4:7], s91 offen offset:2048 nt lds
    s_mov_b32 s41, 0
    s_branch L_qdb10
L_cold:
L_rare0:
    s_nop 7
    s_nop 7
    v_max3_f32 v168, v112, v113, v114
    v_max3_f32 v169, v115, v116, v117
    v_max3_f32 v168, v168, v118, v119
    v_max3_f32 v169, v169, v120, v121
    v_max3_f32 v168, v168, v122, v123
    v_max3_f32 v169, v169, v124, v125
    v_max3_f32 v168, v168, v126, v127
    v_max_f32 v168, v168, v169
    v_mov_b32 v169, v168
    s_nop 1
    v_permlane32_swap_b32 v168, v169
    v_max_f32 v168, v168, v169
    v_mul_f32 v168, s26, v168
    v_max_f32 v168, v168, v13
    v_sub_f32 v169, v13, v168
    v_exp_f32 v169, v169
    v_mov_b32 v13, v168
    v_mul_f32 v14, v14, v169
    v_mul_f32 v16, v16, v169
    v_mul_f32 v17, v17, v169
    v_mul_f32 v18, v18, v169
    v_mul_f32 v19, v19, v169
    v_mul_f32 v20, v20, v169
    v_mul_f32 v21, v21, v169
    v_mul_f32 v22, v22, v169
    v_mul_f32 v23, v23, v169
    v_mul_f32 v24, v24, v169
    v_mul_f32 v25, v25, v169
    v_mul_f32 v26, v26, v169
    v_mul_f32 v27, v27, v169
    v_mul_f32 v28, v28, v169
    v_mul_f32 v29, v29, v169
    v_mul_f32 v30, v30, v169
    v_mul_f32 v31, v31, v169
    v_mul_f32 v32, v32, v169
    v_mul_f32 v33, v33, v169
    v_mul_f32 v34, v34, v169
    v_mul_f32 v35, v35, v169
    v_mul_f32 v36, v36, v169
    v_mul_f32 v37, v37, v169
    v_mul_f32 v38, v38, v169
    v_mul_f32 v39, v39, v169
    v_mul_f32 v40, v40, v169
    v_mul_f32 v41, v41, v169
    v_mul_f32 v42, v42, v169
    v_mul_f32 v43, v43, v169
    v_mul_f32 v44, v44, v169
    v_mul_f32 v45, v45, v169
    v_mul_f32 v46, v46, v169
    v_mul_f32 v47, v47, v169
    v_mul_f32 v48, v48, v169
    v_mul_f32 v49, v49, v169
    v_mul_f32 v50, v50, v169
    v_mul_f32 v51, v51, v169
    v_mul_f32 v52, v52, v169
    v_mul_f32 v53, v53, v169
    v_mul_f32 v54, v54, v169
    v_mul_f32 v55, v55, v169
    v_mul_f32 v56, v56, v169
    v_mul_f32 v57, v57, v169
    v_mul_f32 v58, v58, v169
    v_mul_f32 v59, v59, v169
    v_mul_f32 v60, v60, v169
    v_mul_f32 v61, v61, v169
    v_mul_f32 v62, v62, v169
    v_mul_f32 v63, v63, v169
    v_mul_f32 v64, v64, v169
    v_mul_f32 v65, v65, v169
    v_mul_f32 v66, v66, v169
    v_mul_f32 v67, v67, v169
    v_mul_f32 v68, v68, v169
    v_mul_f32 v69, v69, v169
    v_mul_f32 v70, v70, v169
    v_mul_f32 v71, v71, v169
    v_mul_f32 v72, v72, v169
    v_mul_f32 v73, v73, v169
    v_mul_f32 v74, v74, v169
    v_mul_f32 v75, v75, v169
    v_mul_f32 v76, v76, v169
    v_mul_f32 v77, v77, v169
    v_mul_f32 v78, v78, v169
    v_mul_f32 v79, v79, v169
    v_mul_f32 v80, v80, v169
    v_mul_f32 v81, v81, v169
    v_mul_f32 v82, v82, v169
    v_mul_f32 v83, v83, v169
    v_mul_f32 v84, v84, v169
    v_mul_f32 v85, v85, v169
    v_mul_f32 v86, v86, v169
    v_mul_f32 v87, v87, v169
    v_mul_f32 v88, v88, v169
    v_mul_f32 v89, v89, v169
    v_mul_f32 v90, v90, v169
    v_mul_f32 v91, v91, v169
    v_mul_f32 v92, v92, v169
    v_mul_f32 v93, v93, v169
    v_mul_f32 v94, v94, v169
    v_mul_f32 v95, v95, v169
    v_mul_f32 v96, v96, v169
    v_mul_f32 v97, v97, v169
    v_mul_f32 v98, v98, v169
    v_mul_f32 v99, v99, v169
    v_mul_f32 v100, v100, v169
    v_mul_f32 v101, v101, v169
    v_mul_f32 v102, v102, v169
    v_mul_f32 v103, v103, v169
    v_mul_f32 v104, v104, v169
    v_mul_f32 v105, v105, v169
    v_mul_f32 v106, v106, v169
    v_mul_f32 v107, v107, v169
    v_mul_f32 v108, v108, v169
    v_mul_f32 v109, v109, v169
    v_mul_f32 v110, v110, v169
    v_mul_f32 v111, v111, v169
    v_fma_f32 v160, v112, s26, -v13
    v_fma_f32 v161, v113, s26, -v13
    v_exp_f32 v160, v160
    v_fma_f32 v162, v114, s26, -v13
    v_exp_f32 v161, v161
    v_fma_f32 v163, v115, s26, -v13
    v_exp_f32 v162, v162
    v_fma_f32 v164, v116, s26, -v13
    v_add_f32 v15, v160, v161
    v_cvt_pk_bf16_f32 v144, v160, v161
    v_exp_f32 v163, v163
    v_fma_f32 v165, v117, s26, -v13
    v_add_f32 v15, v15, v162
    v_exp_f32 v164, v164
    v_fma_f32 v166, v118, s26, -v13
    v_add_f32 v15, v15, v163
    v_cvt_pk_bf16_f32 v145, v162, v163
    v_exp_f32 v165, v165
    v_fma_f32 v167, v119, s26, -v13
    v_add_f32 v15, v15, v164
    v_exp_f32 v166, v166
    v_fma_f32 v160, v120, s26, -v13
    v_add_f32 v15, v15, v165
    v_cvt_pk_bf16_f32 v146, v164, v165
    v_exp_f32 v167, v167
    v_fma_f32 v161, v121, s26, -v13
    v_add_f32 v15, v15, v166
    v_exp_f32 v160, v160
    v_fma_f32 v162, v122, s26, -v13
    v_add_f32 v15, v15, v167
    v_cvt_pk_bf16_f32 v147, v166, v167
    v_exp_f32 v161, v161
    v_fma_f32 v163, v123, s26, -v13
    v_add_f32 v15, v15, v160
    v_exp_f32 v162, v162
    v_fma_f32 v164, v124, s26, -v13
    v_add_f32 v15, v15, v161
    v_cvt_pk_bf16_f32 v148, v160, v161
    v_exp_f32 v163, v163
    v_fma_f32 v165, v125, s26, -v13
    v_add_f32 v15, v15, v162
    v_exp_f32 v164, v164
    v_fma_f32 v166, v126, s26, -v13
    v_add_f32 v15, v15, v163
    v_cvt_pk_bf16_f32 v149, v162, v163
    v_exp_f32 v165, v165
    v_fma_f32 v167, v127, s26, -v13
    v_add_f32 v15, v15, v164
    v_exp_f32 v166, v166
    v_exp_f32 v167, v167
    v_add_f32 v15, v15, v165
    v_cvt_pk_bf16_f32 v150, v164, v165
    v_add_f32 v15, v15, v166
    v_add_f32 v15, v15, v167
    v_cvt_pk_bf16_f32 v151, v166, v167
    s_nop 1
    s_branch L_back0
L_rare1:
    s_nop 7
    s_nop 7
    v_max3_f32 v168, v128, v129, v130
    v_max3_f32 v169, v131, v132, v133
    v_max3_f32 v168, v168, v134, v135
    v_max3_f32 v169, v169, v136, v137
    v_max3_f32 v168, v168, v138, v139
    v_max3_f32 v169, v169, v140, v141
    v_max3_f32 v168, v168, v142, v143
    v_max_f32 v168, v168, v169
    v_mov_b32 v169, v168
    s_nop 1
    v_permlane32_swap_b32 v168, v169
    v_max_f32 v168, v168, v169
    v_mul_f32 v168, s26, v168
    v_max_f32 v168, v168, v13
    v_sub_f32 v169, v13, v168
    v_exp_f32 v169, v169
    v_mov_b32 v13, v168
    v_mul_f32 v14, v14, v169
    v_mul_f32 v16, v16, v169
    v_mul_f32 v17, v17, v169
    v_mul_f32 v18, v18, v169
    v_mul_f32 v19, v19, v169
    v_mul_f32 v20, v20, v169
    v_mul_f32 v21, v21, v169
    v_mul_f32 v22, v22, v169
    v_mul_f32 v23, v23, v169
    v_mul_f32 v24, v24, v169
    v_mul_f32 v25, v25, v169
    v_mul_f32 v26, v26, v169
    v_mul_f32 v27, v27, v169
    v_mul_f32 v28, v28, v169
    v_mul_f32 v29, v29, v169
    v_mul_f32 v30, v30, v169
    v_mul_f32 v31, v31, v169
    v_mul_f32 v32, v32, v169
    v_mul_f32 v33, v33, v169
    v_mul_f32 v34, v34, v169
    v_mul_f32 v35, v35, v169
    v_mul_f32 v36, v36, v169
    v_mul_f32 v37, v37, v169
    v_mul_f32 v38, v38, v169
    v_mul_f32 v39, v39, v169
    v_mul_f32 v40, v40, v169
    v_mul_f32 v41, v41, v169
    v_mul_f32 v42, v42, v169
    v_mul_f32 v43, v43, v169
    v_mul_f32 v44, v44, v169
    v_mul_f32 v45, v45, v169
    v_mul_f32 v46, v46, v169
    v_mul_f32 v47, v47, v169
    v_mul_f32 v48, v48, v169
    v_mul_f32 v49, v49, v169
    v_mul_f32 v50, v50, v169
    v_mul_f32 v51, v51, v169
    v_mul_f32 v52, v52, v169
    v_mul_f32 v53, v53, v169
    v_mul_f32 v54, v54, v169
    v_mul_f32 v55, v55, v169
    v_mul_f32 v56, v56, v169
    v_mul_f32 v57, v57, v169
    v_mul_f32 v58, v58, v169
    v_mul_f32 v59, v59, v169
    v_mul_f32 v60, v60, v169
    v_mul_f32 v61, v61, v169
    v_mul_f32 v62, v62, v169
    v_mul_f32 v63, v63, v169
    v_mul_f32 v64, v64, v169
    v_mul_f32 v65, v65, v169
    v_mul_f32 v66, v66, v169
    v_mul_f32 v67, v67, v169
    v_mul_f32 v68, v68, v169
    v_mul_f32 v69, v69, v169
    v_mul_f32 v70, v70, v169
    v_mul_f32 v71, v71, v169
    v_mul_f32 v72, v72, v169
    v_mul_f32 v73, v73, v169
    v_mul_f32 v74, v74, v169
    v_mul_f32 v75, v75, v169
    v_mul_f32 v76, v76, v169
    v_mul_f32 v77, v77, v169
    v_mul_f32 v78, v78, v169
    v_mul_f32 v79, v79, v169
    v_mul_f32 v80, v80, v169
    v_mul_f32 v81, v81, v169
    v_mul_f32 v82, v82, v169
    v_mul_f32 v83, v83, v169
    v_mul_f32 v84, v84, v169
    v_mul_f32 v85, v85, v169
    v_mul_f32 v86, v86, v169
    v_mul_f32 v87, v87, v169
    v_mul_f32 v88, v88, v169
    v_mul_f32 v89, v89, v169
    v_mul_f32 v90, v90, v169
    v_mul_f32 v91, v91, v169
    v_mul_f32 v92, v92, v169
    v_mul_f32 v93, v93, v169
    v_mul_f32 v94, v94, v169
    v_mul_f32 v95, v95, v169
    v_mul_f32 v96, v96, v169
    v_mul_f32 v97, v97, v169
    v_mul_f32 v98, v98, v169
    v_mul_f32 v99, v99, v169
    v_mul_f32 v100, v100, v169
    v_mul_f32 v101, v101, v169
    v_mul_f32 v102, v102, v169
    v_mul_f32 v103, v103, v169
    v_mul_f32 v104, v104, v169
    v_mul_f32 v105, v105, v169
    v_mul_f32 v106, v106, v169
    v_mul_f32 v107, v107, v169
    v_mul_f32 v108, v108, v169
    v_mul_f32 v109, v109, v169
    v_mul_f32 v110, v110, v169
    v_mul_f32 v111, v111, v169
    v_fma_f32 v160, v128, s26, -v13
    v_fma_f32 v161, v129, s26, -v13
    v_exp_f32 v160, v160
    v_fma_f32 v162, v130, s26, -v13
    v_exp_f32 v161, v161
    v_fma_f32 v163, v131, s26, -v13
    v_exp_f32 v162, v162
    v_fma_f32 v164, v132, s26, -v13
    v_add_f32 v15, v160, v161
    v_cvt_pk_bf16_f32 v152, v160, v161
    v_exp_f32 v163, v163
    v_fma_f32 v165, v133, s26, -v13
    v_add_f32 v15, v15, v162
    v_exp_f32 v164, v164
    v_fma_f32 v166, v134, s26, -v13
    v_add_f32 v15, v15, v163
    v_cvt_pk_bf16_f32 v153, v162, v163
    v_exp_f32 v165, v165
    v_fma_f32 v167, v135, s26, -v13
    v_add_f32 v15, v15, v164
    v_exp_f32 v166, v166
    v_fma_f32 v160, v136, s26, -v13
    v_add_f32 v15, v15, v165
    v_cvt_pk_bf16_f32 v154, v164, v165
    v_exp_f32 v167, v167
    v_fma_f32 v161, v137, s26, -v13
    v_add_f32 v15, v15, v166
    v_exp_f32 v160, v160
    v_fma_f32 v162, v138, s26, -v13
    v_add_f32 v15, v15, v167
    v_cvt_pk_bf16_f32 v155, v166, v167
    v_exp_f32 v161, v161
    v_fma_f32 v163, v139, s26, -v13
    v_add_f32 v15, v15, v160
    v_exp_f32 v162, v162
    v_fma_f32 v164, v140, s26, -v13
    v_add_f32 v15, v15, v161
    v_cvt_pk_bf16_f32 v156, v160, v161
    v_exp_f32 v163, v163
    v_fma_f32 v165, v141, s26, -v13
    v_add_f32 v15, v15, v162
    v_exp_f32 v164, v164
    v_fma_f32 v166, v142, s26, -v13
    v_add_f32 v15, v15, v163
    v_cvt_pk_bf16_f32 v157, v162, v163
    v_exp_f32 v165, v165
    v_fma_f32 v167, v143, s26, -v13
    v_add_f32 v15, v15, v164
    v_exp_f32 v166, v166
    v_exp_f32 v167, v167
    v_add_f32 v15, v15, v165
    v_cvt_pk_bf16_f32 v158, v164, v165
    v_add_f32 v15, v15, v166
    v_add_f32 v15, v15, v167
    v_cvt_pk_bf16_f32 v159, v166, v167
    s_nop 1
    s_branch L_back1
L_rareL:
    s_nop 7
    s_nop 7
    v_max3_f32 v168, v112, v113, v114
    v_max3_f32 v169, v115, v116, v117
    v_max3_f32 v168, v168, v118, v119
    v_max3_f32 v169, v169, v120, v121
    v_max3_f32 v168, v168, v122, v123
    v_max3_f32 v169, v169, v124, v125
    v_max3_f32 v168, v168, v126, v127
    v_max_f32 v168, v168, v169
    v_mov_b32 v169, v168
    s_nop 1
    v_permlane32_swap_b32 v168, v169
    v_max_f32 v168, v168, v169
    v_mul_f32 v168, s26, v168
    v_max_f32 v168, v168, v13
    v_sub_f32 v169, v13, v168
    v_exp_f32 v169, v169
    v_mov_b32 v13, v168
    v_mul_f32 v14, v14, v169
    v_mul_f32 v16, v16, v169
    v_mul_f32 v17, v17, v169
    v_mul_f32 v18, v18, v169
    v_mul_f32 v19, v19, v169
    v_mul_f32 v20, v20, v169
    v_mul_f32 v21, v21, v169
    v_mul_f32 v22, v22, v169
    v_mul_f32 v23, v23, v169
    v_mul_f32 v24, v24, v169
    v_mul_f32 v25, v25, v169
    v_mul_f32 v26, v26, v169
    v_mul_f32 v27, v27, v169
    v_mul_f32 v28, v28, v169
    v_mul_f32 v29, v29, v169
    v_mul_f32 v30, v30, v169
    v_mul_f32 v31, v31, v169
    v_mul_f32 v32, v32, v169
    v_mul_f32 v33, v33, v169
    v_mul_f32 v34, v34, v169
    v_mul_f32 v35, v35, v169
    v_mul_f32 v36, v36, v169
    v_mul_f32 v37, v37, v169
    v_mul_f32 v38, v38, v169
    v_mul_f32 v39, v39, v169
    v_mul_f32 v40, v40, v169
    v_mul_f32 v41, v41, v169
    v_mul_f32 v42, v42, v169
    v_mul_f32 v43, v43, v169
    v_mul_f32 v44, v44, v169
    v_mul_f32 v45, v45, v169
    v_mul_f32 v46, v46, v169
    v_mul_f32 v47, v47, v169
    v_mul_f32 v48, v48, v169
    v_mul_f32 v49, v49, v169
    v_mul_f32 v50, v50, v169
    v_mul_f32 v51, v51, v169
    v_mul_f32 v52, v52, v169
    v_mul_f32 v53, v53, v169
    v_mul_f32 v54, v54, v169
    v_mul_f32 v55, v55, v169
    v_mul_f32 v56, v56, v169
    v_mul_f32 v57, v57, v169
    v_mul_f32 v58, v58, v169
    v_mul_f32 v59, v59, v169
    v_mul_f32 v60, v60, v169
    v_mul_f32 v61, v61, v169
    v_mul_f32 v62, v62, v169
    v_mul_f32 v63, v63, v169
    v_mul_f32 v64, v64, v169
    v_mul_f32 v65, v65, v169
    v_mul_f32 v66, v66, v169
    v_mul_f32 v67, v67, v169
    v_mul_f32 v68, v68, v169
    v_mul_f32 v69, v69, v169
    v_mul_f32 v70, v70, v169
    v_mul_f32 v71, v71, v169
    v_mul_f32 v72, v72, v169
    v_mul_f32 v73, v73, v169
    v_mul_f32 v74, v74, v169
    v_mul_f32 v75, v75, v169
    v_mul_f32 v76, v76, v169
    v_mul_f32 v77, v77, v169
    v_mul_f32 v78, v78, v169
    v_mul_f32 v79, v79, v169
    v_mul_f32 v80, v80, v169
    v_mul_f32 v81, v81, v169
    v_mul_f32 v82, v82, v169
    v_mul_f32 v83, v83, v169
    v_mul_f32 v84, v84, v169
    v_mul_f32 v85, v85, v169
    v_mul_f32 v86, v86, v169
    v_mul_f32 v87, v87, v169
    v_mul_f32 v88, v88, v169
    v_mul_f32 v89, v89, v169
    v_mul_f32 v90, v90, v169
    v_mul_f32 v91, v91, v169
    v_mul_f32 v92, v92, v169
    v_mul_f32 v93, v93, v169
    v_mul_f32 v94, v94, v169
    v_mul_f32 v95, v95, v169
    v_mul_f32 v96, v96, v169
    v_mul_f32 v97, v97, v169
    v_mul_f32 v98, v98, v169
    v_mul_f32 v99, v99, v169
    v_mul_f32 v100, v100, v169
    v_mul_f32 v101, v101, v169
    v_mul_f32 v102, v102, v169
    v_mul_f32 v103, v103, v169
    v_mul_f32 v104, v104, v169
    v_mul_f32 v105, v105, v169
    v_mul_f32 v106, v106, v169
    v_mul_f32 v107, v107, v169
    v_mul_f32 v108, v108, v169
    v_mul_f32 v109, v109, v169
    v_mul_f32 v110, v110, v169
    v_mul_f32 v111, v111, v169
    v_fma_f32 v160, v112, s26, -v13
    v_fma_f32 v161, v113, s26, -v13
    v_exp_f32 v160, v160
    v_fma_f32 v162, v114, s26, -v13
    v_exp_f32 v161, v161
    v_fma_f32 v163, v115, s26, -v13
    v_exp_f32 v162, v162
    v_fma_f32 v164, v116, s26, -v13
    v_add_f32 v15, v160, v161
    v_cvt_pk_bf16_f32 v144, v160, v161
    v_exp_f32 v163, v163
    v_fma_f32 v165, v117, s26, -v13
    v_add_f32 v15, v15, v162
    v_exp_f32 v164, v164
    v_fma_f32 v166, v118, s26, -v13
    v_add_f32 v15, v15, v163
    v_cvt_pk_bf16_f32 v145, v162, v163
    v_exp_f32 v165, v165
    v_fma_f32 v167, v119, s26, -v13
    v_add_f32 v15, v15, v164
    v_exp_f32 v166, v166
    v_fma_f32 v160, v120, s26, -v13
    v_add_f32 v15, v15, v165
    v_cvt_pk_bf16_f32 v146, v164, v165
    v_exp_f32 v167, v167
    v_fma_f32 v161, v121, s26, -v13
    v_add_f32 v15, v15, v166
    v_exp_f32 v160, v160
    v_fma_f32 v162, v122, s26, -v13
    v_add_f32 v15, v15, v167
    v_cvt_pk_bf16_f32 v147, v166, v167
    v_exp_f32 v161, v161
    v_fma_f32 v163, v123, s26, -v13
    v_add_f32 v15, v15, v160
    v_exp_f32 v162, v162
    v_fma_f32 v164, v124, s26, -v13
    v_add_f32 v15, v15, v161
    v_cvt_pk_bf16_f32 v148, v160, v161
    v_exp_f32 v163, v163
    v_fma_f32 v165, v125, s26, -v13
    v_add_f32 v15, v15, v162
    v_exp_f32 v164, v164
    v_fma_f32 v166, v126, s26, -v13
    v_add_f32 v15, v15, v163
    v_cvt_pk_bf16_f32 v149, v162, v163
    v_exp_f32 v165, v165
    v_fma_f32 v167, v127, s26, -v13
    v_add_f32 v15, v15, v164
    v_exp_f32 v166, v166
    v_exp_f32 v167, v167
    v_add_f32 v15, v15, v165
    v_cvt_pk_bf16_f32 v150, v164, v165
    v_add_f32 v15, v15, v166
    v_add_f32 v15, v15, v167
    v_cvt_pk_bf16_f32 v151, v166, v167
    s_nop 1
    s_branch L_backL
L_rareA:
    s_nop 7
    s_nop 7
    v_max3_f32 v168, v112, v113, v114
    v_max3_f32 v169, v115, v116, v117
    v_max3_f32 v168, v168, v118, v119
    v_max3_f32 v169, v169, v120, v121
    v_max3_f32 v168, v168, v122, v123
    v_max3_f32 v169, v169, v124, v125
    v_max3_f32 v168, v168, v126, v127
    v_max_f32 v168, v168, v169
    v_mov_b32 v169, v168
    s_nop 1
    v_permlane32_swap_b32 v168, v169
    v_max_f32 v168, v168, v169
    v_mul_f32 v168, s26, v168
    v_max_f32 v168, v168, v13
    v_sub_f32 v169, v13, v168
    v_exp_f32 v169, v169
    v_mov_b32 v13, v168
    v_mul_f32 v14, v14, v169
    v_mul_f32 v16, v16, v169
    v_mul_f32 v17, v17, v169
    v_mul_f32 v18, v18, v169
    v_mul_f32 v19, v19, v169
    v_mul_f32 v20, v20, v169
    v_mul_f32 v21, v21, v169
    v_mul_f32 v22, v22, v169
    v_mul_f32 v23, v23, v169
    v_mul_f32 v24, v24, v169
    v_mul_f32 v25, v25, v169
    v_mul_f32 v26, v26, v169
    v_mul_f32 v27, v27, v169
    v_mul_f32 v28, v28, v169
    v_mul_f32 v29, v29, v169
    v_mul_f32 v30, v30, v169
    v_mul_f32 v31, v31, v169
    v_mul_f32 v32, v32, v169
    v_mul_f32 v33, v33, v169
    v_mul_f32 v34, v34, v169
    v_mul_f32 v35, v35, v169
    v_mul_f32 v36, v36, v169
    v_mul_f32 v37, v37, v169
    v_mul_f32 v38, v38, v169
    v_mul_f32 v39, v39, v169
    v_mul_f32 v40, v40, v169
    v_mul_f32 v41, v41, v169
    v_mul_f32 v42, v42, v169
    v_mul_f32 v43, v43, v169
    v_mul_f32 v44, v44, v169
    v_mul_f32 v45, v45, v169
    v_mul_f32 v46, v46, v169
    v_mul_f32 v47, v47, v169
    v_mul_f32 v48, v48, v169
    v_mul_f32 v49, v49, v169
    v_mul_f32 v50, v50, v169
    v_mul_f32 v51, v51, v169
    v_mul_f32 v52, v52, v169
    v_mul_f32 v53, v53, v169
    v_mul_f32 v54, v54, v169
    v_mul_f32 v55, v55, v169
    v_mul_f32 v56, v56, v169
    v_mul_f32 v57, v57, v169
    v_mul_f32 v58, v58, v169
    v_mul_f32 v59, v59, v169
    v_mul_f32 v60, v60, v169
    v_mul_f32 v61, v61, v169
    v_mul_f32 v62, v62, v169
    v_mul_f32 v63, v63, v169
    v_mul_f32 v64, v64, v169
    v_mul_f32 v65, v65, v169
    v_mul_f32 v66, v66, v169
    v_mul_f32 v67, v67, v169
    v_mul_f32 v68, v68, v169
    v_mul_f32 v69, v69, v169
    v_mul_f32 v70, v70, v169
    v_mul_f32 v71, v71, v169
    v_mul_f32 v72, v72, v169
    v_mul_f32 v73, v73, v169
    v_mul_f32 v74, v74, v169
    v_mul_f32 v75, v75, v169
    v_mul_f32 v76, v76, v169
    v_mul_f32 v77, v77, v169
    v_mul_f32 v78, v78, v169
    v_mul_f32 v79, v79, v169
    v_mul_f32 v80, v80, v169
    v_mul_f32 v81, v81, v169
    v_mul_f32 v82, v82, v169
    v_mul_f32 v83, v83, v169
    v_mul_f32 v84, v84, v169
    v_mul_f32 v85, v85, v169
    v_mul_f32 v86, v86, v169
    v_mul_f32 v87, v87, v169
    v_mul_f32 v88, v88, v169
    v_mul_f32 v89, v89, v169
    v_mul_f32 v90, v90, v169
    v_mul_f32 v91, v91, v169
    v_mul_f32 v92, v92, v169
    v_mul_f32 v93, v93, v169
    v_mul_f32 v94, v94, v169
    v_mul_f32 v95, v95, v169
    v_mul_f32 v96, v96, v169
    v_mul_f32 v97, v97, v169
    v_mul_f32 v98, v98, v169
    v_mul_f32 v99, v99, v169
    v_mul_f32 v100, v100, v169
    v_mul_f32 v101, v101, v169
    v_mul_f32 v102, v102, v169
    v_mul_f32 v103, v103, v169
    v_mul_f32 v104, v104, v169
    v_mul_f32 v105, v105, v169
    v_mul_f32 v106, v106, v169
    v_mul_f32 v107, v107, v169
    v_mul_f32 v108, v108, v169
    v_mul_f32 v109, v109, v169
    v_mul_f32 v110, v110, v169
    v_mul_f32 v111, v111, v169
    v_fma_f32 v160, v112, s26, -v13
    v_fma_f32 v161, v113, s26, -v13
    v_exp_f32 v160, v160
    v_fma_f32 v162, v114, s26, -v13
    v_exp_f32 v161, v161
    v_fma_f32 v163, v115, s26, -v13
    v_exp_f32 v162, v162
    v_fma_f32 v164, v116, s26, -v13
    v_add_f32 v15, v160, v161
    v_cvt_pk_bf16_f32 v144, v160, v161
    v_exp_f32 v163, v163
    v_fma_f32 v165, v117, s26, -v13
    v_add_f32 v15, v15, v162
    v_exp_f32 v164, v164
    v_fma_f32 v166, v118, s26, -v13
    v_add_f32 v15, v15, v163
    v_cvt_pk_bf16_f32 v145, v162, v163
    v_exp_f32 v165, v165
    v_fma_f32 v167, v119, s26, -v13
    v_add_f32 v15, v15, v164
    v_exp_f32 v166, v166
    v_fma_f32 v160, v120, s26, -v13
    v_add_f32 v15, v15, v165
    v_cvt_pk_bf16_f32 v146, v164, v165
    v_exp_f32 v167, v167
    v_fma_f32 v161, v121, s26, -v13
    v_add_f32 v15, v15, v166
    v_exp_f32 v160, v160
    v_fma_f32 v162, v122, s26, -v13
    v_add_f32 v15, v15, v167
    v_cvt_pk_bf16_f32 v147, v166, v167
    v_exp_f32 v161, v161
    v_fma_f32 v163, v123, s26, -v13
    v_add_f32 v15, v15, v160
    v_exp_f32 v162, v162
    v_fma_f32 v164, v124, s26, -v13
    v_add_f32 v15, v15, v161
    v_cvt_pk_bf16_f32 v148, v160, v161
    v_exp_f32 v163, v163
    v_fma_f32 v165, v125, s26, -v13
    v_add_f32 v15, v15, v162
    v_exp_f32 v164, v164
    v_fma_f32 v166, v126, s26, -v13
    v_add_f32 v15, v15, v163
    v_cvt_pk_bf16_f32 v149, v162, v163
    v_exp_f32 v165, v165
    v_fma_f32 v167, v127, s26, -v13
    v_add_f32 v15, v15, v164
    v_exp_f32 v166, v166
    v_exp_f32 v167, v167
    v_add_f32 v15, v15, v165
    v_cvt_pk_bf16_f32 v150, v164, v165
    v_add_f32 v15, v15, v166
    v_add_f32 v15, v15, v167
    v_cvt_pk_bf16_f32 v151, v166, v167
    s_nop 1
    s_branch L_backA
L_rareB:
    s_nop 7
    s_nop 7
    v_max3_f32 v168, v128, v129, v130
    v_max3_f32 v169, v131, v132, v133
    v_max3_f32 v168, v168, v134, v135
    v_max3_f32 v169, v169, v136, v137
    v_max3_f32 v168, v168, v138, v139
    v_max3_f32 v169, v169, v140, v141
    v_max3_f32 v168, v168, v142, v143
    v_max_f32 v168, v168, v169
    v_mov_b32 v169, v168
    s_nop 1
    v_permlane32_swap_b32 v168, v169
    v_max_f32 v168, v168, v169
    v_mul_f32 v168, s26, v168
    v_max_f32 v168, v168, v13
    v_sub_f32 v169, v13, v168
    v_exp_f32 v169, v169
    v_mov_b32 v13, v168
    v_mul_f32 v14, v14, v169
    v_mul_f32 v16, v16, v169
    v_mul_f32 v17, v17, v169
    v_mul_f32 v18, v18, v169
    v_mul_f32 v19, v19, v169
    v_mul_f32 v20, v20, v169
    v_mul_f32 v21, v21, v169
    v_mul_f32 v22, v22, v169
    v_mul_f32 v23, v23, v169
    v_mul_f32 v24, v24, v169
    v_mul_f32 v25, v25, v169
    v_mul_f32 v26, v26, v169
    v_mul_f32 v27, v27, v169
    v_mul_f32 v28, v28, v169
    v_mul_f32 v29, v29, v169
    v_mul_f32 v30, v30, v169
    v_mul_f32 v31, v31, v169
    v_mul_f32 v32, v32, v169
    v_mul_f32 v33, v33, v169
    v_mul_f32 v34, v34, v169
    v_mul_f32 v35, v35, v169
    v_mul_f32 v36, v36, v169
    v_mul_f32 v37, v37, v169
    v_mul_f32 v38, v38, v169
    v_mul_f32 v39, v39, v169
    v_mul_f32 v40, v40, v169
    v_mul_f32 v41, v41, v169
    v_mul_f32 v42, v42, v169
    v_mul_f32 v43, v43, v169
    v_mul_f32 v44, v44, v169
    v_mul_f32 v45, v45, v169
    v_mul_f32 v46, v46, v169
    v_mul_f32 v47, v47, v169
    v_mul_f32 v48, v48, v169
    v_mul_f32 v49, v49, v169
    v_mul_f32 v50, v50, v169
    v_mul_f32 v51, v51, v169
    v_mul_f32 v52, v52, v169
    v_mul_f32 v53, v53, v169
    v_mul_f32 v54, v54, v169
    v_mul_f32 v55, v55, v169
    v_mul_f32 v56, v56, v169
    v_mul_f32 v57, v57, v169
    v_mul_f32 v58, v58, v169
    v_mul_f32 v59, v59, v169
    v_mul_f32 v60, v60, v169
    v_mul_f32 v61, v61, v169
    v_mul_f32 v62, v62, v169
    v_mul_f32 v63, v63, v169
    v_mul_f32 v64, v64, v169
    v_mul_f32 v65, v65, v169
    v_mul_f32 v66, v66, v169
    v_mul_f32 v67, v67, v169
    v_mul_f32 v68, v68, v169
    v_mul_f32 v69, v69, v169
    v_mul_f32 v70, v70, v169
    v_mul_f32 v71, v71, v169
    v_mul_f32 v72, v72, v169
    v_mul_f32 v73, v73, v169
    v_mul_f32 v74, v74, v169
    v_mul_f32 v75, v75, v169
    v_mul_f32 v76, v76, v169
    v_mul_f32 v77, v77, v169
    v_mul_f32 v78, v78, v169
    v_mul_f32 v79, v79, v169
    v_mul_f32 v80, v80, v169
    v_mul_f32 v81, v81, v169
    v_mul_f32 v82, v82, v169
    v_mul_f32 v83, v83, v169
    v_mul_f32 v84, v84, v169
    v_mul_f32 v85, v85, v169
    v_mul_f32 v86, v86, v169
    v_mul_f32 v87, v87, v169
    v_mul_f32 v88, v88, v169
    v_mul_f32 v89, v89, v169
    v_mul_f32 v90, v90, v169
    v_mul_f32 v91, v91, v169
    v_mul_f32 v92, v92, v169
    v_mul_f32 v93, v93, v169
    v_mul_f32 v94, v94, v169
    v_mul_f32 v95, v95, v169
    v_mul_f32 v96, v96, v169
    v_mul_f32 v97, v97, v169
    v_mul_f32 v98, v98, v169
    v_mul_f32 v99, v99, v169
    v_mul_f32 v100, v100, v169
    v_mul_f32 v101, v101, v169
    v_mul_f32 v102, v102, v169
    v_mul_f32 v103, v103, v169
    v_mul_f32 v104, v104, v169
    v_mul_f32 v105, v105, v169
    v_mul_f32 v106, v106, v169
    v_mul_f32 v107, v107, v169
    v_mul_f32 v108, v108, v169
    v_mul_f32 v109, v109, v169
    v_mul_f32 v110, v110, v169
    v_mul_f32 v111, v111, v169
    v_fma_f32 v160, v128, s26, -v13
    v_fma_f32 v161, v129, s26, -v13
    v_exp_f32 v160, v160
    v_fma_f32 v162, v130, s26, -v13
    v_exp_f32 v161, v161
    v_fma_f32 v163, v131, s26, -v13
    v_exp_f32 v162, v162
    v_fma_f32 v164, v132, s26, -v13
    v_add_f32 v15, v160, v161
    v_cvt_pk_bf16_f32 v152, v160, v161
    v_exp_f32 v163, v163
    v_fma_f32 v165, v133, s26, -v13
    v_add_f32 v15, v15, v162
    v_exp_f32 v164, v164
    v_fma_f32 v166, v134, s26, -v13
    v_add_f32 v15, v15, v163
    v_cvt_pk_bf16_f32 v153, v162, v163
    v_exp_f32 v165, v165
    v_fma_f32 v167, v135, s26, -v13
    v_add_f32 v15, v15, v164
    v_exp_f32 v166, v166
    v_fma_f32 v160, v136, s26, -v13
    v_add_f32 v15, v15, v165
    v_cvt_pk_bf16_f32 v154, v164, v165
    v_exp_f32 v167, v167
    v_fma_f32 v161, v137, s26, -v13
    v_add_f32 v15, v15, v166
    v_exp_f32 v160, v160
    v_fma_f32 v162, v138, s26, -v13
    v_add_f32 v15, v15, v167
    v_cvt_pk_bf16_f32 v155, v166, v167
    v_exp_f32 v161, v161
    v_fma_f32 v163, v139, s26, -v13
    v_add_f32 v15, v15, v160
    v_exp_f32 v162, v162
    v_fma_f32 v164, v140, s26, -v13
    v_add_f32 v15, v15, v161
    v_cvt_pk_bf16_f32 v156, v160, v161
    v_exp_f32 v163, v163
    v_fma_f32 v165, v141, s26, -v13
    v_add_f32 v15, v15, v162
    v_exp_f32 v164, v164
    v_fma_f32 v166, v142, s26, -v13
    v_add_f32 v15, v15, v163
    v_cvt_pk_bf16_f32 v157, v162, v163
    v_exp_f32 v165, v165
    v_fma_f32 v167, v143, s26, -v13
    v_add_f32 v15, v15, v164
    v_exp_f32 v166, v166
    v_exp_f32 v167, v167
    v_add_f32 v15, v15, v165
    v_cvt_pk_bf16_f32 v158, v164, v165
    v_add_f32 v15, v15, v166
    v_add_f32 v15, v15, v167
    v_cvt_pk_bf16_f32 v159, v166, v167
    s_nop 1
    s_branch L_backB
.p2align 7
.type L_duty,@object
L_duty:
    .long 2146435072, 2146435072, 2146435072, 2146435072, 2146435072, 2146435072, 2146435072, 2146435072
    .long 2146435072, 2146435072, 2146435072, 2146435072, 2146435072, 2146435072, 2146435072, 2146435072
    .long 2146435072, 2146435072, 2146435072, 2146435072, 2146435072, 2146435072, 2146435072, 2146435072
    .long 2146435072, 2146435072, 2146435072, 2146435072, 2146435072, 2146435072, 2146435072, 2146435072
    .long 2146435072, 2146435072, 2146435072, 2146435072, 2146435072, 2146435072, 2146435072, 2146435072
    .long 2146435072, 2146435072, 2146435072, 2146435072, 2146435072, 2146435072, 2146435072, 2146435072
    .long 2146435072, 2146435072, 2146435072, 2146435072, 2146435072, 2146435072, 2146435072, 2146435072
    .long 2146435072, 2146435072, 2146435072, 2146435072, 2146435072, 2146435072, 2146435072, 2146435072
    .long 2146435072, 2146435072, 2146435072, 2146435072, 2146435072, 2146435072, 2146435072, 2146435072
    .long 2146435072, 2146435072, 2146435072, 2146435072, 2146435072, 2146435072, 2146435072, 2146435072
    .long 2146435072, 2146435072, 2146435072, 2146435072, 2146435072, 2146435072, 2146435072, 2146435072
    .long 2146435072, 2146435072, 2146435072, 2146435072, 2146435072, 2146435072, 2146435072, 2146435072
    .long 2146435072, 2146435072, 6061056, 2146435072, 2146435072, 3366912, 2146435072, 1081344
    .long 2146435072, 2146435072, 2088960, 2146435072, 2146435072, 1376256, 2146435072, 7240704
    .long 2146435072, 2146435072, 5962752, 7142400, 2146435072, 3268608, 2146435072, 2146435072
    .long 2146435072, 2146435072, 1990656, 3170304, 2146435072, 1277952, 2146435072, 2146435072
    .long 2146435072, 6061056, 2146435072, 1179648, 2146435072, 2146435072, 7044096, 2146435072
    .long 2146435072, 2088960, 2146435072, 7339008, 2146435072, 2146435072, 3072000, 2146435072
    .long 2146435072, 2146435072, 2146435072, 2146435072, 2146435072, 2146435072, 2146435072, 2146435072
    .long 2146435072, 2146435072, 2146435072, 2146435072, 2146435072, 2146435072, 2146435072, 2146435072
    .long 2146435072, 2146435072, 2146435072, 2146435072, 2146435072, 2146435072, 2146435072, 2146435072
    .long 2146435072, 2146435072, 2146435072, 2146435072, 2146435072, 2146435072, 2146435072, 2146435072
    .long 2146435072, 2146435072, 2146435072, 2146435072, 2146435072, 2146435072, 2146435072, 2146435072
    .long 2146435072, 2146435072, 2146435072, 2146435072, 2146435072, 2146435072, 2146435072, 2146435072
    .long 2146435072, 5962752, 2146435072, 3366912, 393216, 2146435072, 1081344, 2285568
    .long 2146435072, 1990656, 2146435072, 1376256, 98304, 2146435072, 7240704, 294912
    .long 14383104, 3268608, 2383872, 4687872, 2146435072, 4291584, 2146435072, 2146435072
    .long 6438912, 1277952, 393216, 3505152, 2146435072, 2146435072, 4291584, 2146435072
    .long 2457600, 2146435072, 7142400, 2383872, 491520, 2146435072, 2146435072, 2146435072
    .long 14284800, 2146435072, 3170304, 393216, 6912000, 2146435072, 1652736, 1474560
    .long 6340608, 1474560, 1179648, 2146435072, 0, 7044096, 2285568, 5935104
    .long 2359296, 5148672, 7339008, 5935104, 6813696, 3072000, 294912, 2146435072
.type L_table,@object
L_table:
    .long 2752528, 3108864, 0, 0, 1376256, 1277952, 1554432, 0
    .long 2753296, 3108864, 0, 0, 1376640, 1278336, 1554432, 0
    .long 2754064, 3108864, 0, 0, 1377024, 1278720, 1554432, 0
    .long 2754832, 3108864, 0, 0, 1377408, 1279104, 1554432, 0
    .long 2755600, 3108864, 0, 0, 1377792, 1279488, 1554432, 0
    .long 2756368, 3108864, 0, 0, 1378176, 1279872, 1554432, 0
    .long 2757136, 3108864, 0, 0, 1378560, 1280256, 1554432, 0
    .long 2757904, 3108864, 0, 0, 1378944, 1280640, 1554432, 0
    .long 6733872, 6813696, 0, 0, 3366912, 3268608, 3406848, 0
    .long 6734640, 6813696, 0, 0, 3367296, 3268992, 3406848, 0
    .long 6735408, 6813696, 0, 0, 3367680, 3269376, 3406848, 0
    .long 6736176, 6813696, 0, 0, 3368064, 3269760, 3406848, 0
    .long 6736944, 6813696, 0, 0, 3368448, 3270144, 3406848, 0
    .long 6737712, 6813696, 0, 0, 3368832, 3270528, 3406848, 0
    .long 6738480, 6813696, 0, 0, 3369216, 3270912, 3406848, 0
    .long 6739248, 6813696, 0, 0, 3369600, 3271296, 3406848, 0
    .long 14678064, 14739456, 0, 0, 7339008, 7240704, 7369728, 0
    .long 14678832, 14739456, 0, 0, 7339392, 7241088, 7369728, 0
    .long 14679600, 14739456, 0, 0, 7339776, 7241472, 7369728, 0
    .long 14680368, 14739456, 0, 0, 7340160, 7241856, 7369728, 0
    .long 14681136, 14739456, 0, 0, 7340544, 7242240, 7369728, 0
    .long 14681904, 14739456, 0, 0, 7340928, 7242624, 7369728, 0
    .long 14682672, 14739456, 0, 0, 7341312, 7243008, 7369728, 0
    .long 14683440, 14739456, 0, 0, 7341696, 7243392, 7369728, 0
    .long 2359310, 3108864, 0, 0, 1179648, 1081344, 7369728, 0
    .long 2360078, 3108864, 0, 0, 1180032, 1081728, 7369728, 0
    .long 2360846, 3108864, 0, 0, 1180416, 1082112, 7369728, 0
    .long 2361614, 3108864, 0, 0, 1180800, 1082496, 7369728, 0
    .long 2362382, 3108864, 0, 0, 1181184, 1082880, 7369728, 0
    .long 2363150, 3108864, 0, 0, 1181568, 1083264, 7369728, 0
    .long 2363918, 3108864, 0, 0, 1181952, 1083648, 7369728, 0
    .long 2364686, 3108864, 0, 0, 1182336, 1084032, 7369728, 0
    .long 6340622, 6813696, 0, 0, 3170304, 3072000, 7369728, 0
    .long 6341390, 6813696, 0, 0, 3170688, 3072384, 7369728, 0
    .long 6342158, 6813696, 0, 0, 3171072, 3072768, 7369728, 0
    .long 6342926, 6813696, 0, 0, 3171456, 3073152, 7369728, 0
    .long 6343694, 6813696, 0, 0, 3171840, 3073536, 7369728, 0
    .long 6344462, 6813696, 0, 0, 3172224, 3073920, 7369728, 0
    .long 6345230, 6813696, 0, 0, 3172608, 3074304, 7369728, 0
    .long 6345998, 6813696, 0, 0, 3172992, 3074688, 7369728, 0
    .long 14284814, 14739456, 0, 0, 7142400, 7044096, 7369728, 0
    .long 14285582, 14739456, 0, 0, 7142784, 7044480, 7369728, 0
    .long 14286350, 14739456, 0, 0, 7143168, 7044864, 7369728, 0
    .long 14287118, 14739456, 0, 0, 7143552, 7045248, 7369728, 0
    .long 14287886, 14739456, 0, 0, 7143936, 7045632, 7369728, 0
    .long 14288654, 14739456, 0, 0, 7144320, 7046016, 7369728, 0
    .long 14289422, 14739456, 0, 0, 7144704, 7046400, 7369728, 0
    .long 14290190, 14739456, 0, 0, 7145088, 7046784, 7369728, 0
    .long 1966092, 3108864, 0, 0, 983040, 884736, 7369728, 0
    .long 1966860, 3108864, 0, 0, 983424, 885120, 7369728, 0
    .long 1967628, 3108864, 0, 0, 983808, 885504, 7369728, 0
    .long 1968396, 3108864, 0, 0, 984192, 885888, 7369728, 0
    .long 1969164, 3108864, 0, 0, 984576, 886272, 7369728, 0
    .long 1969932, 3108864, 0, 0, 984960, 886656, 7369728, 0
    .long 1970700, 3108864, 0, 0, 985344, 887040, 7369728, 0
    .long 1971468, 3108864, 0, 0, 985728, 887424, 7369728, 0
    .long 5947404, 6813696, 0, 0, 2973696, 2875392, 7369728, 0
    .long 5948172, 6813696, 0, 0, 2974080, 2875776, 7369728, 0
    .long 5948940, 6813696, 0, 0, 2974464, 2876160, 7369728, 0
    .long 5949708, 6813696, 0, 0, 2974848, 2876544, 7369728, 0
    .long 5950476, 6813696, 0, 0, 2975232, 2876928, 7369728, 0
    .long 5951244, 6813696, 0, 0, 2975616, 2877312, 7369728, 0
    .long 5952012, 6813696, 0, 0, 2976000, 2877696, 7369728, 0
    .long 5952780, 6813696, 0, 0, 2976384, 2878080, 7369728, 0
    .long 13891596, 14739456, 0, 0, 6945792, 6847488, 7369728, 0
    .long 13892364, 14739456, 0, 0, 6946176, 6847872, 7369728, 0
    .long 13893132, 14739456, 0, 0, 6946560, 6848256, 7369728, 0
    .long 13893900, 14739456, 0, 0, 6946944, 6848640, 7369728, 0
    .long 13894668, 14739456, 0, 0, 6947328, 6849024, 7369728, 0
    .long 13895436, 14739456, 0, 0, 6947712, 6849408, 7369728, 0
    .long 13896204, 14739456, 0, 0, 6948096, 6849792, 7369728, 0
    .long 13896972, 14739456, 0, 0, 6948480, 6850176, 7369728, 0
    .long 3502084, 3981312, 393220, 3108864, 1751040, 1849344, 7369728, 0
    .long 3502852, 3981312, 393988, 3108864, 1751424, 1849728, 7369728, 0
    .long 3503620, 3981312, 394756, 3108864, 1751808, 1850112, 7369728, 0
    .long 3504388, 3981312, 395524, 3108864, 1752192, 1850496, 7369728, 0
    .long 3505156, 3981312, 396292, 3108864, 1752576, 1850880, 7369728, 0
    .long 3505924, 3981312, 397060, 3108864, 1752960, 1851264, 7369728, 0
    .long 3506692, 3981312, 397828, 3108864, 1753344, 1851648, 7369728, 0
    .long 3507460, 3981312, 398596, 3108864, 1753728, 1852032, 7369728, 0
    .long 786438, 3108864, 6813698, 8699904, 393216, 294912, 7369728, 0
    .long 787206, 3108864, 6814466, 8699904, 393600, 295296, 7369728, 0
    .long 787974, 3108864, 6815234, 8699904, 393984, 295680, 7369728, 0
    .long 788742, 3108864, 6816002, 8699904, 394368, 296064, 7369728, 0
    .long 789510, 3108864, 6816770, 8699904, 394752, 296448, 7369728, 0
    .long 790278, 3108864, 6817538, 8699904, 395136, 296832, 7369728, 0
    .long 791046, 3108864, 6818306, 8699904, 395520, 297216, 7369728, 0
    .long 791814, 3108864, 6819074, 8699904, 395904, 297600, 7369728, 0
    .long 4767750, 6813696, 2, 3108864, 2383872, 2285568, 7369728, 0
    .long 4768518, 6813696, 770, 3108864, 2384256, 2285952, 7369728, 0
    .long 4769286, 6813696, 1538, 3108864, 2384640, 2286336, 7369728, 0
    .long 4770054, 6813696, 2306, 3108864, 2385024, 2286720, 7369728, 0
    .long 4770822, 6813696, 3074, 3108864, 2385408, 2287104, 7369728, 0
    .long 4771590, 6813696, 3842, 3108864, 2385792, 2287488, 7369728, 0
    .long 4772358, 6813696, 4610, 3108864, 2386176, 2287872, 7369728, 0
    .long 4773126, 6813696, 5378, 3108864, 2386560, 2288256, 7369728, 0
    .long 1572874, 3108864, 0, 0, 786432, 688128, 7369728, 0
    .long 1573642, 3108864, 0, 0, 786816, 688512, 7369728, 0
    .long 1574410, 3108864, 0, 0, 787200, 688896, 7369728, 0
    .long 1575178, 3108864, 0, 0, 787584, 689280, 7369728, 0
    .long 1575946, 3108864, 0, 0, 787968, 689664, 7369728, 0
    .long 1576714, 3108864, 0, 0, 788352, 690048, 7369728, 0
    .long 1577482, 3108864, 0, 0, 788736, 690432, 7369728, 0
    .long 1578250, 3108864, 0, 0, 789120, 690816, 7369728, 0
    .long 5554186, 6813696, 0, 0, 2777088, 2678784, 7369728, 0
    .long 5554954, 6813696, 0, 0, 2777472, 2679168, 7369728, 0
    .long 5555722, 6813696, 0, 0, 2777856, 2679552, 7369728, 0
    .long 5556490, 6813696, 0, 0, 2778240, 2679936, 7369728, 0
    .long 5557258, 6813696, 0, 0, 2778624, 2680320, 7369728, 0
    .long 5558026, 6813696, 0, 0, 2779008, 2680704, 7369728, 0
    .long 5558794, 6813696, 0, 0, 2779392, 2681088, 7369728, 0
    .long 5559562, 6813696, 0, 0, 2779776, 2681472, 7369728, 0
    .long 8386570, 8699904, 0, 0, 4193280, 4094976, 4349952, 0
    .long 8387338, 8699904, 0, 0, 4193664, 4095360, 4349952, 0
    .long 8388106, 8699904, 0, 0, 4194048, 4095744, 4349952, 0
    .long 8388874, 8699904, 0, 0, 4194432, 4096128, 4349952, 0
    .long 8389642, 8699904, 0, 0, 4194816, 4096512, 4349952, 0
    .long 8390410, 8699904, 0, 0, 4195200, 4096896, 4349952, 0
    .long 8391178, 8699904, 0, 0, 4195584, 4097280, 4349952, 0
    .long 8391946, 8699904, 0, 0, 4195968, 4097664, 4349952, 0
    .long 11673610, 11925504, 0, 0, 5836800, 5738496, 5962752, 0
    .long 11674378, 11925504, 0, 0, 5837184, 5738880, 5962752, 0
    .long 11675146, 11925504, 0, 0, 5837568, 5739264, 5962752, 0
    .long 11675914, 11925504, 0, 0, 5837952, 5739648, 5962752, 0
    .long 11676682, 11925504, 0, 0, 5838336, 5740032, 5962752, 0
    .long 11677450, 11925504, 0, 0, 5838720, 5740416, 5962752, 0
    .long 11678218, 11925504, 0, 0, 5839104, 5740800, 5962752, 0
    .long 11678986, 11925504, 0, 0, 5839488, 5741184, 5962752, 0
    .long 13498378, 14739456, 0, 0, 6749184, 6650880, 7369728, 0
    .long 13499146, 14739456, 0, 0, 6749568, 6651264, 7369728, 0
    .long 13499914, 14739456, 0, 0, 6749952, 6651648, 7369728, 0
    .long 13500682, 14739456, 0, 0, 6750336, 6652032, 7369728, 0
    .long 13501450, 14739456, 0, 0, 6750720, 6652416, 7369728, 0
    .long 13502218, 14739456, 0, 0, 6751104, 6652800, 7369728, 0
    .long 13502986, 14739456, 0, 0, 6751488, 6653184, 7369728, 0
    .long 13503754, 14739456, 0, 0, 6751872, 6653568, 7369728, 0
    .long 4374532, 6813696, 9093156, 9179136, 2187264, 2285568, 4589568, 0
    .long 4375300, 6813696, 9093924, 9179136, 2187648, 2285952, 4589568, 0
    .long 4376068, 6813696, 9094692, 9179136, 2188032, 2286336, 4589568, 0
    .long 4376836, 6813696, 9095460, 9179136, 2188416, 2286720, 4589568, 0
    .long 4377604, 6813696, 9096228, 9179136, 2188800, 2287104, 4589568, 0
    .long 4378372, 6813696, 9096996, 9179136, 2189184, 2287488, 4589568, 0
    .long 4379140, 6813696, 9097764, 9179136, 2189568, 2287872, 4589568, 0
    .long 4379908, 6813696, 9098532, 9179136, 2189952, 2288256, 4589568, 0
    .long 3895334, 3981312, 3108866, 3981312, 1947648, 1849344, 1990656, 0
    .long 3896102, 3981312, 3109634, 3981312, 1948032, 1849728, 1990656, 0
    .long 3896870, 3981312, 3110402, 3981312, 1948416, 1850112, 1990656, 0
    .long 3897638, 3981312, 3111170, 3981312, 1948800, 1850496, 1990656, 0
    .long 3898406, 3981312, 3111938, 3981312, 1949184, 1850880, 1990656, 0
    .long 3899174, 3981312, 3112706, 3981312, 1949568, 1851264, 1990656, 0
    .long 3899942, 3981312, 3113474, 3981312, 1949952, 1851648, 1990656, 0
    .long 3900710, 3981312, 3114242, 3981312, 1950336, 1852032, 1990656, 0
    .long 9965606, 10100736, 3981314, 6813696, 4982784, 4884480, 5050368, 0
    .long 9966374, 10100736, 3982082, 6813696, 4983168, 4884864, 5050368, 0
    .long 9967142, 10100736, 3982850, 6813696, 4983552, 4885248, 5050368, 0
    .long 9967910, 10100736, 3983618, 6813696, 4983936, 4885632, 5050368, 0
    .long 9968678, 10100736, 3984386, 6813696, 4984320, 4886016, 5050368, 0
    .long 9969446, 10100736, 3985154, 6813696, 4984704, 4886400, 5050368, 0
    .long 9970214, 10100736, 3985922, 6813696, 4985088, 4886784, 5050368, 0
    .long 9970982, 10100736, 3986690, 6813696, 4985472, 4887168, 5050368, 0
    .long 7206916, 8699904, 11925506, 14739456, 3603456, 3701760, 7369728, 0
    .long 7207684, 8699904, 11926274, 14739456, 3603840, 3702144, 7369728, 0
    .long 7208452, 8699904, 11927042, 14739456, 3604224, 3702528, 7369728, 0
    .long 7209220, 8699904, 11927810, 14739456, 3604608, 3702912, 7369728, 0
    .long 7209988, 8699904, 11928578, 14739456, 3604992, 3703296, 7369728, 0
    .long 7210756, 8699904, 11929346, 14739456, 3605376, 3703680, 7369728, 0
    .long 7211524, 8699904, 11930114, 14739456, 3605760, 3704064, 7369728, 0
    .long 7212292, 8699904, 11930882, 14739456, 3606144, 3704448, 7369728, 0
    .long 9572356, 10100736, 10100738, 11925504, 4786176, 4884480, 7369728, 0
    .long 9573124, 10100736, 10101506, 11925504, 4786560, 4884864, 7369728, 0
    .long 9573892, 10100736, 10102274, 11925504, 4786944, 4885248, 7369728, 0
    .long 9574660, 10100736, 10103042, 11925504, 4787328, 4885632, 7369728, 0
    .long 9575428, 10100736, 10103810, 11925504, 4787712, 4886016, 7369728, 0
    .long 9576196, 10100736, 10104578, 11925504, 4788096, 4886400, 7369728, 0
    .long 9576964, 10100736, 10105346, 11925504, 4788480, 4886784, 7369728, 0
    .long 9577732, 10100736, 10106114, 11925504, 4788864, 4887168, 7369728, 0
    .long 10493956, 11925504, 9179138, 10100736, 5246976, 5345280, 7369728, 0
    .long 10494724, 11925504, 9179906, 10100736, 5247360, 5345664, 7369728, 0
    .long 10495492, 11925504, 9180674, 10100736, 5247744, 5346048, 7369728, 0
    .long 10496260, 11925504, 9181442, 10100736, 5248128, 5346432, 7369728, 0
    .long 10497028, 11925504, 9182210, 10100736, 5248512, 5346816, 7369728, 0
    .long 10497796, 11925504, 9182978, 10100736, 5248896, 5347200, 7369728, 0
    .long 10498564, 11925504, 9183746, 10100736, 5249280, 5347584, 7369728, 0
    .long 10499332, 11925504, 9184514, 10100736, 5249664, 5347968, 7369728, 0
    .long 12318724, 14739456, 8699906, 9179136, 6159360, 6257664, 7369728, 0
    .long 12319492, 14739456, 8700674, 9179136, 6159744, 6258048, 7369728, 0
    .long 12320260, 14739456, 8701442, 9179136, 6160128, 6258432, 7369728, 0
    .long 12321028, 14739456, 8702210, 9179136, 6160512, 6258816, 7369728, 0
    .long 12321796, 14739456, 8702978, 9179136, 6160896, 6259200, 7369728, 0
    .long 12322564, 14739456, 8703746, 9179136, 6161280, 6259584, 7369728, 0
    .long 12323332, 14739456, 8704514, 9179136, 6161664, 6259968, 7369728, 0
    .long 12324100, 14739456, 8705282, 9179136, 6162048, 6260352, 7369728, 0
    .long 1179656, 3108864, 0, 0, 589824, 491520, 7369728, 0
    .long 1180424, 3108864, 0, 0, 590208, 491904, 7369728, 0
    .long 1181192, 3108864, 0, 0, 590592, 492288, 7369728, 0
    .long 1181960, 3108864, 0, 0, 590976, 492672, 7369728, 0
    .long 1182728, 3108864, 0, 0, 591360, 493056, 7369728, 0
    .long 1183496, 3108864, 0, 0, 591744, 493440, 7369728, 0
    .long 1184264, 3108864, 0, 0, 592128, 493824, 7369728, 0
    .long 1185032, 3108864, 0, 0, 592512, 494208, 7369728, 0
    .long 5160968, 6813696, 0, 0, 2580480, 2482176, 7369728, 0
    .long 5161736, 6813696, 0, 0, 2580864, 2482560, 7369728, 0
    .long 5162504, 6813696, 0, 0, 2581248, 2482944, 7369728, 0
    .long 5163272, 6813696, 0, 0, 2581632, 2483328, 7369728, 0
    .long 5164040, 6813696, 0, 0, 2582016, 2483712, 7369728, 0
    .long 5164808, 6813696, 0, 0, 2582400, 2484096, 7369728, 0
    .long 5165576, 6813696, 0, 0, 2582784, 2484480, 7369728, 0
    .long 5166344, 6813696, 0, 0, 2583168, 2484864, 7369728, 0
    .long 7993352, 8699904, 0, 0, 3996672, 3898368, 7369728, 0
    .long 7994120, 8699904, 0, 0, 3997056, 3898752, 7369728, 0
    .long 7994888, 8699904, 0, 0, 3997440, 3899136, 7369728, 0
    .long 7995656, 8699904, 0, 0, 3997824, 3899520, 7369728, 0
    .long 7996424, 8699904, 0, 0, 3998208, 3899904, 7369728, 0
    .long 7997192, 8699904, 0, 0, 3998592, 3900288, 7369728, 0
    .long 7997960, 8699904, 0, 0, 3998976, 3900672, 7369728, 0
    .long 7998728, 8699904, 0, 0, 3999360, 3901056, 7369728, 0
    .long 11280392, 11925504, 0, 0, 5640192, 5541888, 7369728, 0
    .long 11281160, 11925504, 0, 0, 5640576, 5542272, 7369728, 0
    .long 11281928, 11925504, 0, 0, 5640960, 5542656, 7369728, 0
    .long 11282696, 11925504, 0, 0, 5641344, 5543040, 7369728, 0
    .long 11283464, 11925504, 0, 0, 5641728, 5543424, 7369728, 0
    .long 11284232, 11925504, 0, 0, 5642112, 5543808, 7369728, 0
    .long 11285000, 11925504, 0, 0, 5642496, 5544192, 7369728, 0
    .long 11285768, 11925504, 0, 0, 5642880, 5544576, 7369728, 0
    .long 13105160, 14739456, 0, 0, 6552576, 6454272, 7369728, 0
    .long 13105928, 14739456, 0, 0, 6552960, 6454656, 7369728, 0
    .long 13106696, 14739456, 0, 0, 6553344, 6455040, 7369728, 0
    .long 13107464, 14739456, 0, 0, 6553728, 6455424, 7369728, 0
    .long 13108232, 14739456, 0, 0, 6554112, 6455808, 7369728, 0
    .long 13109000, 14739456, 0, 0, 6554496, 6456192, 7369728, 0
    .long 13109768, 14739456, 0, 0, 6554880, 6456576, 7369728, 0
    .long 13110536, 14739456, 0, 0, 6555264, 6456960, 7369728, 0
    .long 7600134, 8699904, 0, 0, 3800064, 3701760, 7369728, 0
    .long 7600902, 8699904, 0, 0, 3800448, 3702144, 7369728, 0
    .long 7601670, 8699904, 0, 0, 3800832, 3702528, 7369728, 0
    .long 7602438, 8699904, 0, 0, 3801216, 3702912, 7369728, 0
    .long 7603206, 8699904, 0, 0, 3801600, 3703296, 7369728, 0
    .long 7603974, 8699904, 0, 0, 3801984, 3703680, 7369728, 0
    .long 7604742, 8699904, 0, 0, 3802368, 3704064, 7369728, 0
    .long 7605510, 8699904, 0, 0, 3802752, 3704448, 7369728, 0
    .long 10887174, 11925504, 0, 0, 5443584, 5345280, 7369728, 0
    .long 10887942, 11925504, 0, 0, 5443968, 5345664, 7369728, 0
    .long 10888710, 11925504, 0, 0, 5444352, 5346048, 7369728, 0
    .long 10889478, 11925504, 0, 0, 5444736, 5346432, 7369728, 0
    .long 10890246, 11925504, 0, 0, 5445120, 5346816, 7369728, 0
    .long 10891014, 11925504, 0, 0, 5445504, 5347200, 7369728, 0
    .long 10891782, 11925504, 0, 0, 5445888, 5347584, 7369728, 0
    .long 10892550, 11925504, 0, 0, 5446272, 5347968, 7369728, 0
    .long 12711942, 14739456, 0, 0, 6355968, 6257664, 7369728, 0
    .long 12712710, 14739456, 0, 0, 6356352, 6258048, 7369728, 0
    .long 12713478, 14739456, 0, 0, 6356736, 6258432, 7369728, 0
    .long 12714246, 14739456, 0, 0, 6357120, 6258816, 7369728, 0
    .long 12715014, 14739456, 0, 0, 6357504, 6259200, 7369728, 0
    .long 12715782, 14739456, 0, 0, 6357888, 6259584, 7369728, 0
    .long 12716550, 14739456, 0, 0, 6358272, 6259968, 7369728, 0
    .long 12717318, 14739456, 0, 0, 6358656, 6260352, 7369728, 0
.type L_steps,@object
L_steps:
    .long 0, 98304, 1376256, 1277952, 1179648, 1081344, 983040, 884736, 786432, 688128, 589824, 491520, 393216, 294912, 196608, 1474560, 2146435072, 2146435072, 2146435072, 2146435072, 2146435072, 2146435072, 2146435072, 2146435072, 2146435072, 2146435072, 2146435072, 2146435072, 2146435072, 2146435072, 2146435072, 2146435072
    .long 384, 98688, 1376640, 1278336, 1180032, 1081728, 983424, 885120, 786816, 688512, 590208, 491904, 393600, 295296, 196992, 1474944, 2146435072, 2146435072, 2146435072, 2146435072, 2146435072, 2146435072, 2146435072, 2146435072, 2146435072, 2146435072, 2146435072, 2146435072, 2146435072, 2146435072, 2146435072, 2146435072
    .long 768, 99072, 1377024, 1278720, 1180416, 1082112, 983808, 885504, 787200, 688896, 590592, 492288, 393984, 295680, 197376, 1475328, 2146435072, 2146435072, 2146435072, 2146435072, 2146435072, 2146435072, 2146435072, 2146435072, 2146435072, 2146435072, 2146435072, 2146435072, 2146435072, 2146435072, 2146435072, 2146435072
    .long 1152, 99456, 1377408, 1279104, 1180800, 1082496, 984192, 885888, 787584, 689280, 590976, 492672, 394368, 296064, 197760, 1475712, 2146435072, 2146435072, 2146435072, 2146435072, 2146435072, 2146435072, 2146435072, 2146435072, 2146435072, 2146435072, 2146435072, 2146435072, 2146435072, 2146435072, 2146435072, 2146435072
    .long 1536, 99840, 1377792, 1279488, 1181184, 1082880, 984576, 886272, 787968, 689664, 591360, 493056, 394752, 296448, 198144, 1476096, 2146435072, 2146435072, 2146435072, 2146435072, 2146435072, 2146435072, 2146435072, 2146435072, 2146435072, 2146435072, 2146435072, 2146435072, 2146435072, 2146435072, 2146435072, 2146435072
    .long 1920, 100224, 1378176, 1279872, 1181568, 1083264, 984960, 886656, 788352, 690048, 591744, 493440, 395136, 296832, 198528, 1476480, 2146435072, 2146435072, 2146435072, 2146435072, 2146435072, 2146435072, 2146435072, 2146435072, 2146435072, 2146435072, 2146435072, 2146435072, 2146435072, 2146435072, 2146435072, 2146435072
    .long 2304, 100608, 1378560, 1280256, 1181952, 1083648, 985344, 887040, 788736, 690432, 592128, 493824, 395520, 297216, 198912, 1476864, 2146435072, 2146435072, 2146435072, 2146435072, 2146435072, 2146435072, 2146435072, 2146435072, 2146435072, 2146435072, 2146435072, 2146435072, 2146435072, 2146435072, 2146435072, 2146435072
    .long 2688, 100992, 1378944, 1280640, 1182336, 1084032, 985728, 887424, 789120, 690816, 592512, 494208, 395904, 297600, 199296, 1477248, 2146435072, 2146435072, 2146435072, 2146435072, 2146435072, 2146435072, 2146435072, 2146435072, 2146435072, 2146435072, 2146435072, 2146435072, 2146435072, 2146435072, 2146435072, 2146435072
    .long 1990656, 2088960, 3366912, 3268608, 3170304, 3072000, 2973696, 2875392, 2777088, 2678784, 2580480, 2482176, 2383872, 2285568, 2187264, 3465216, 2146435072, 2146435072, 2146435072, 2146435072, 2146435072, 2146435072, 2146435072, 2146435072, 2146435072, 2146435072, 2146435072, 2146435072, 2146435072, 2146435072, 2146435072, 2146435072
    .long 1991040, 2089344, 3367296, 3268992, 3170688, 3072384, 2974080, 2875776, 2777472, 2679168, 2580864, 2482560, 2384256, 2285952, 2187648, 3465600, 2146435072, 2146435072, 2146435072, 2146435072, 2146435072, 2146435072, 2146435072, 2146435072, 2146435072, 2146435072, 2146435072, 2146435072, 2146435072, 2146435072, 2146435072, 2146435072
    .long 1991424, 2089728, 3367680, 3269376, 3171072, 3072768, 2974464, 2876160, 2777856, 2679552, 2581248, 2482944, 2384640, 2286336, 2188032, 3465984, 2146435072, 2146435072, 2146435072, 2146435072, 2146435072, 2146435072, 2146435072, 2146435072, 2146435072, 2146435072, 2146435072, 2146435072, 2146435072, 2146435072, 2146435072, 2146435072
    .long 1991808, 2090112, 3368064, 3269760, 3171456, 3073152, 2974848, 2876544, 2778240, 2679936, 2581632, 2483328, 2385024, 2286720, 2188416, 3466368, 2146435072, 2146435072, 2146435072, 2146435072, 2146435072, 2146435072, 2146435072, 2146435072, 2146435072, 2146435072, 2146435072, 2146435072, 2146435072, 2146435072, 2146435072, 2146435072
    .long 1992192, 2090496, 3368448, 3270144, 3171840, 3073536, 2975232, 2876928, 2778624, 2680320, 2582016, 2483712, 2385408, 2287104, 2188800, 3466752, 2146435072, 2146435072, 2146435072, 2146435072, 2146435072, 2146435072, 2146435072, 2146435072, 2146435072, 2146435072, 2146435072, 2146435072, 2146435072, 2146435072, 2146435072, 2146435072
    .long 1992576, 2090880, 3368832, 3270528, 3172224, 3073920, 2975616, 2877312, 2779008, 2680704, 2582400, 2484096, 2385792, 2287488, 2189184, 3467136, 2146435072, 2146435072, 2146435072, 2146435072, 2146435072, 2146435072, 2146435072, 2146435072, 2146435072, 2146435072, 2146435072, 2146435072, 2146435072, 2146435072, 2146435072, 2146435072
    .long 1992960, 2091264, 3369216, 3270912, 3172608, 3074304, 2976000, 2877696, 2779392, 2681088, 2582784, 2484480, 2386176, 2287872, 2189568, 3467520, 2146435072, 2146435072, 2146435072, 2146435072, 2146435072, 2146435072, 2146435072, 2146435072, 2146435072, 2146435072, 2146435072, 2146435072, 2146435072, 2146435072, 2146435072, 2146435072
    .long 1993344, 2091648, 3369600, 3271296, 3172992, 3074688, 2976384, 2878080, 2779776, 2681472, 2583168, 2484864, 2386560, 2288256, 2189952, 3467904, 2146435072, 2146435072, 2146435072, 2146435072, 2146435072, 2146435072, 2146435072, 2146435072, 2146435072, 2146435072, 2146435072, 2146435072, 2146435072, 2146435072, 2146435072, 2146435072
    .long 5962752, 6061056, 7339008, 7240704, 7142400, 7044096, 6945792, 6847488, 6749184, 6650880, 6552576, 6454272, 6355968, 6257664, 6159360, 7437312, 2146435072, 2146435072, 2146435072, 2146435072, 2146435072, 2146435072, 2146435072, 2146435072, 2146435072, 2146435072, 2146435072, 2146435072, 2146435072, 2146435072, 2146435072, 2146435072
    .long 5963136, 6061440, 7339392, 7241088, 7142784, 7044480, 6946176, 6847872, 6749568, 6651264, 6552960, 6454656, 6356352, 6258048, 6159744, 7437696, 2146435072, 2146435072, 2146435072, 2146435072, 2146435072, 2146435072, 2146435072, 2146435072, 2146435072, 2146435072, 2146435072, 2146435072, 2146435072, 2146435072, 2146435072, 2146435072
    .long 5963520, 6061824, 7339776, 7241472, 7143168, 7044864, 6946560, 6848256, 6749952, 6651648, 6553344, 6455040, 6356736, 6258432, 6160128, 7438080, 2146435072, 2146435072, 2146435072, 2146435072, 2146435072, 2146435072, 2146435072, 2146435072, 2146435072, 2146435072, 2146435072, 2146435072, 2146435072, 2146435072, 2146435072, 2146435072
    .long 5963904, 6062208, 7340160, 7241856, 7143552, 7045248, 6946944, 6848640, 6750336, 6652032, 6553728, 6455424, 6357120, 6258816, 6160512, 7438464, 2146435072, 2146435072, 2146435072, 2146435072, 2146435072, 2146435072, 2146435072, 2146435072, 2146435072, 2146435072, 2146435072, 2146435072, 2146435072, 2146435072, 2146435072, 2146435072
    .long 5964288, 6062592, 7340544, 7242240, 7143936, 7045632, 6947328, 6849024, 6750720, 6652416, 6554112, 6455808, 6357504, 6259200, 6160896, 7438848, 2146435072, 2146435072, 2146435072, 2146435072, 2146435072, 2146435072, 2146435072, 2146435072, 2146435072, 2146435072, 2146435072, 2146435072, 2146435072, 2146435072, 2146435072, 2146435072
    .long 5964672, 6062976, 7340928, 7242624, 7144320, 7046016, 6947712, 6849408, 6751104, 6652800, 6554496, 6456192, 6357888, 6259584, 6161280, 7439232, 2146435072, 2146435072, 2146435072, 2146435072, 2146435072, 2146435072, 2146435072, 2146435072, 2146435072, 2146435072, 2146435072, 2146435072, 2146435072, 2146435072, 2146435072, 2146435072
    .long 5965056, 6063360, 7341312, 7243008, 7144704, 7046400, 6948096, 6849792, 6751488, 6653184, 6554880, 6456576, 6358272, 6259968, 6161664, 7439616, 2146435072, 2146435072, 2146435072, 2146435072, 2146435072, 2146435072, 2146435072, 2146435072, 2146435072, 2146435072, 2146435072, 2146435072, 2146435072, 2146435072, 2146435072, 2146435072
    .long 5965440, 6063744, 7341696, 7243392, 7145088, 7046784, 6948480, 6850176, 6751872, 6653568, 6555264, 6456960, 6358656, 6260352, 6162048, 7440000, 2146435072, 2146435072, 2146435072, 2146435072, 2146435072, 2146435072, 2146435072, 2146435072, 2146435072, 2146435072, 2146435072, 2146435072, 2146435072, 2146435072, 2146435072, 2146435072
    .long 0, 98304, 1179648, 1081344, 983040, 884736, 786432, 688128, 589824, 491520, 393216, 294912, 196608, 1277952, 2146435072, 2146435072, 2146435072, 2146435072, 2146435072, 2146435072, 2146435072, 2146435072, 2146435072, 2146435072, 2146435072, 2146435072, 2146435072, 2146435072, 2146435072, 2146435072, 2146435072, 2146435072
    .long 384, 98688, 1180032, 1081728, 983424, 885120, 786816, 688512, 590208, 491904, 393600, 295296, 196992, 1278336, 2146435072, 2146435072, 2146435072, 2146435072, 2146435072, 2146435072, 2146435072, 2146435072, 2146435072, 2146435072, 2146435072, 2146435072, 2146435072, 2146435072, 2146435072, 2146435072, 2146435072, 2146435072
    .long 768, 99072, 1180416, 1082112, 983808, 885504, 787200, 688896, 590592, 492288, 393984, 295680, 197376, 1278720, 2146435072, 2146435072, 2146435072, 2146435072, 2146435072, 2146435072, 2146435072, 2146435072, 2146435072, 2146435072, 2146435072, 2146435072, 2146435072, 2146435072, 2146435072, 2146435072, 2146435072, 2146435072
    .long 1152, 99456, 1180800, 1082496, 984192, 885888, 787584, 689280, 590976, 492672, 394368, 296064, 197760, 1279104, 2146435072, 2146435072, 2146435072, 2146435072, 2146435072, 2146435072, 2146435072, 2146435072, 2146435072, 2146435072, 2146435072, 2146435072, 2146435072, 2146435072, 2146435072, 2146435072, 2146435072, 2146435072
    .long 1536, 99840, 1181184, 1082880, 984576, 886272, 787968, 689664, 591360, 493056, 394752, 296448, 198144, 1279488, 2146435072, 2146435072, 2146435072, 2146435072, 2146435072, 2146435072, 2146435072, 2146435072, 2146435072, 2146435072, 2146435072, 2146435072, 2146435072, 2146435072, 2146435072, 2146435072, 2146435072, 2146435072
    .long 1920, 100224, 1181568, 1083264, 984960, 886656, 788352, 690048, 591744, 493440, 395136, 296832, 198528, 1279872, 2146435072, 2146435072, 2146435072, 2146435072, 2146435072, 2146435072, 2146435072, 2146435072, 2146435072, 2146435072, 2146435072, 2146435072, 2146435072, 2146435072, 2146435072, 2146435072, 2146435072, 2146435072
    .long 2304, 100608, 1181952, 1083648, 985344, 887040, 788736, 690432, 592128, 493824, 395520, 297216, 198912, 1280256, 2146435072, 2146435072, 2146435072, 2146435072, 2146435072, 2146435072, 2146435072, 2146435072, 2146435072, 2146435072, 2146435072, 2146435072, 2146435072, 2146435072, 2146435072, 2146435072, 2146435072, 2146435072
    .long 2688, 100992, 1182336, 1084032, 985728, 887424, 789120, 690816, 592512, 494208, 395904, 297600, 199296, 1280640, 2146435072, 2146435072, 2146435072, 2146435072, 2146435072, 2146435072, 2146435072, 2146435072, 2146435072, 2146435072, 2146435072, 2146435072, 2146435072, 2146435072, 2146435072, 2146435072, 2146435072, 2146435072
    .long 1990656, 2088960, 3170304, 3072000, 2973696, 2875392, 2777088, 2678784, 2580480, 2482176, 2383872, 2285568, 2187264, 3268608, 2146435072, 2146435072, 2146435072, 2146435072, 2146435072, 2146435072, 2146435072, 2146435072, 2146435072, 2146435072, 2146435072, 2146435072, 2146435072, 2146435072, 2146435072, 2146435072, 2146435072, 2146435072
    .long 1991040, 2089344, 3170688, 3072384, 2974080, 2875776, 2777472, 2679168, 2580864, 2482560, 2384256, 2285952, 2187648, 3268992, 2146435072, 2146435072, 2146435072, 2146435072, 2146435072, 2146435072, 2146435072, 2146435072, 2146435072, 2146435072, 2146435072, 2146435072, 2146435072, 2146435072, 2146435072, 2146435072, 2146435072, 2146435072
    .long 1991424, 2089728, 3171072, 3072768, 2974464, 2876160, 2777856, 2679552, 2581248, 2482944, 2384640, 2286336, 2188032, 3269376, 2146435072, 2146435072, 2146435072, 2146435072, 2146435072, 2146435072, 2146435072, 2146435072, 2146435072, 2146435072, 2146435072, 2146435072, 2146435072, 2146435072, 2146435072, 2146435072, 2146435072, 2146435072
    .long 1991808, 2090112, 3171456, 3073152, 2974848, 2876544, 2778240, 2679936, 2581632, 2483328, 2385024, 2286720, 2188416, 3269760, 2146435072, 2146435072, 2146435072, 2146435072, 2146435072, 2146435072, 2146435072, 2146435072, 2146435072, 2146435072, 2146435072, 2146435072, 2146435072, 2146435072, 2146435072, 2146435072, 2146435072, 2146435072
    .long 1992192, 2090496, 3171840, 3073536, 2975232, 2876928, 2778624, 2680320, 2582016, 2483712, 2385408, 2287104, 2188800, 3270144, 2146435072, 2146435072, 2146435072, 2146435072, 2146435072, 2146435072, 2146435072, 2146435072, 2146435072, 2146435072, 2146435072, 2146435072, 2146435072, 2146435072, 2146435072, 2146435072, 2146435072, 2146435072
    .long 1992576, 2090880, 3172224, 3073920, 2975616, 2877312, 2779008, 2680704, 2582400, 2484096, 2385792, 2287488, 2189184, 3270528, 2146435072, 2146435072, 2146435072, 2146435072, 2146435072, 2146435072, 2146435072, 2146435072, 2146435072, 2146435072, 2146435072, 2146435072, 2146435072, 2146435072, 2146435072, 2146435072, 2146435072, 2146435072
    .long 1992960, 2091264, 3172608, 3074304, 2976000, 2877696, 2779392, 2681088, 2582784, 2484480, 2386176, 2287872, 2189568, 3270912, 2146435072, 2146435072, 2146435072, 2146435072, 2146435072, 2146435072, 2146435072, 2146435072, 2146435072, 2146435072, 2146435072, 2146435072, 2146435072, 2146435072, 2146435072, 2146435072, 2146435072, 2146435072
    .long 1993344, 2091648, 3172992, 3074688, 2976384, 2878080, 2779776, 2681472, 2583168, 2484864, 2386560, 2288256, 2189952, 3271296, 2146435072, 2146435072, 2146435072, 2146435072, 2146435072, 2146435072, 2146435072, 2146435072, 2146435072, 2146435072, 2146435072, 2146435072, 2146435072, 2146435072, 2146435072, 2146435072, 2146435072, 2146435072
    .long 5962752, 6061056, 7142400, 7044096, 6945792, 6847488, 6749184, 6650880, 6552576, 6454272, 6355968, 6257664, 6159360, 7240704, 2146435072, 2146435072, 2146435072, 2146435072, 2146435072, 2146435072, 2146435072, 2146435072, 2146435072, 2146435072, 2146435072, 2146435072, 2146435072, 2146435072, 2146435072, 2146435072, 2146435072, 2146435072
    .long 5963136, 6061440, 7142784, 7044480, 6946176, 6847872, 6749568, 6651264, 6552960, 6454656, 6356352, 6258048, 6159744, 7241088, 2146435072, 2146435072, 2146435072, 2146435072, 2146435072, 2146435072, 2146435072, 2146435072, 2146435072, 2146435072, 2146435072, 2146435072, 2146435072, 2146435072, 2146435072, 2146435072, 2146435072, 2146435072
    .long 5963520, 6061824, 7143168, 7044864, 6946560, 6848256, 6749952, 6651648, 6553344, 6455040, 6356736, 6258432, 6160128, 7241472, 2146435072, 2146435072, 2146435072, 2146435072, 2146435072, 2146435072, 2146435072, 2146435072, 2146435072, 2146435072, 2146435072, 2146435072, 2146435072, 2146435072, 2146435072, 2146435072, 2146435072, 2146435072
    .long 5963904, 6062208, 7143552, 7045248, 6946944, 6848640, 6750336, 6652032, 6553728, 6455424, 6357120, 6258816, 6160512, 7241856, 2146435072, 2146435072, 2146435072, 2146435072, 2146435072, 2146435072, 2146435072, 2146435072, 2146435072, 2146435072, 2146435072, 2146435072, 2146435072, 2146435072, 2146435072, 2146435072, 2146435072, 2146435072
    .long 5964288, 6062592, 7143936, 7045632, 6947328, 6849024, 6750720, 6652416, 6554112, 6455808, 6357504, 6259200, 6160896, 7242240, 2146435072, 2146435072, 2146435072, 2146435072, 2146435072, 2146435072, 2146435072, 2146435072, 2146435072, 2146435072, 2146435072, 2146435072, 2146435072, 2146435072, 2146435072, 2146435072, 2146435072, 2146435072
    .long 5964672, 6062976, 7144320, 7046016, 6947712, 6849408, 6751104, 6652800, 6554496, 6456192, 6357888, 6259584, 6161280, 7242624, 2146435072, 2146435072, 2146435072, 2146435072, 2146435072, 2146435072, 2146435072, 2146435072, 2146435072, 2146435072, 2146435072, 2146435072, 2146435072, 2146435072, 2146435072, 2146435072, 2146435072, 2146435072
    .long 5965056, 6063360, 7144704, 7046400, 6948096, 6849792, 6751488, 6653184, 6554880, 6456576, 6358272, 6259968, 6161664, 7243008, 2146435072, 2146435072, 2146435072, 2146435072, 2146435072, 2146435072, 2146435072, 2146435072, 2146435072, 2146435072, 2146435072, 2146435072, 2146435072, 2146435072, 2146435072, 2146435072, 2146435072, 2146435072
    .long 5965440, 6063744, 7145088, 7046784, 6948480, 6850176, 6751872, 6653568, 6555264, 6456960, 6358656, 6260352, 6162048, 7243392, 2146435072, 2146435072, 2146435072, 2146435072, 2146435072, 2146435072, 2146435072, 2146435072, 2146435072, 2146435072, 2146435072, 2146435072, 2146435072, 2146435072, 2146435072, 2146435072, 2146435072, 2146435072
    .long 0, 98304, 983040, 884736, 786432, 688128, 589824, 491520, 393216, 294912, 196608, 1081344, 2146435072, 2146435072, 2146435072, 2146435072, 2146435072, 2146435072, 2146435072, 2146435072, 2146435072, 2146435072, 2146435072, 2146435072, 2146435072, 2146435072, 2146435072, 2146435072, 2146435072, 2146435072, 2146435072, 2146435072
    .long 384, 98688, 983424, 885120, 786816, 688512, 590208, 491904, 393600, 295296, 196992, 1081728, 2146435072, 2146435072, 2146435072, 2146435072, 2146435072, 2146435072, 2146435072, 2146435072, 2146435072, 2146435072, 2146435072, 2146435072, 2146435072, 2146435072, 2146435072, 2146435072, 2146435072, 2146435072, 2146435072, 2146435072
    .long 768, 99072, 983808, 885504, 787200, 688896, 590592, 492288, 393984, 295680, 197376, 1082112, 2146435072, 2146435072, 2146435072, 2146435072, 2146435072, 2146435072, 2146435072, 2146435072, 2146435072, 2146435072, 2146435072, 2146435072, 2146435072, 2146435072, 2146435072, 2146435072, 2146435072, 2146435072, 2146435072, 2146435072
    .long 1152, 99456, 984192, 885888, 787584, 689280, 590976, 492672, 394368, 296064, 197760, 1082496, 2146435072, 2146435072, 2146435072, 2146435072, 2146435072, 2146435072, 2146435072, 2146435072, 2146435072, 2146435072, 2146435072, 2146435072, 2146435072, 2146435072, 2146435072, 2146435072, 2146435072, 2146435072, 2146435072, 2146435072
    .long 1536, 99840, 984576, 886272, 787968, 689664, 591360, 493056, 394752, 296448, 198144, 1082880, 2146435072, 2146435072, 2146435072, 2146435072, 2146435072, 2146435072, 2146435072, 2146435072, 2146435072, 2146435072, 2146435072, 2146435072, 2146435072, 2146435072, 2146435072, 2146435072, 2146435072, 2146435072, 2146435072, 2146435072
    .long 1920, 100224, 984960, 886656, 788352, 690048, 591744, 493440, 395136, 296832, 198528, 1083264, 2146435072, 2146435072, 2146435072, 2146435072, 2146435072, 2146435072, 2146435072, 2146435072, 2146435072, 2146435072, 2146435072, 2146435072, 2146435072, 2146435072, 2146435072, 2146435072, 2146435072, 2146435072, 2146435072, 2146435072
    .long 2304, 100608, 985344, 887040, 788736, 690432, 592128, 493824, 395520, 297216, 198912, 1083648, 2146435072, 2146435072, 2146435072, 2146435072, 2146435072, 2146435072, 2146435072, 2146435072, 2146435072, 2146435072, 2146435072, 2146435072, 2146435072, 2146435072, 2146435072, 2146435072, 2146435072, 2146435072, 2146435072, 2146435072
    .long 2688, 100992, 985728, 887424, 789120, 690816, 592512, 494208, 395904, 297600, 199296, 1084032, 2146435072, 2146435072, 2146435072, 2146435072, 2146435072, 2146435072, 2146435072, 2146435072, 2146435072, 2146435072, 2146435072, 2146435072, 2146435072, 2146435072, 2146435072, 2146435072, 2146435072, 2146435072, 2146435072, 2146435072
    .long 1990656, 2088960, 2973696, 2875392, 2777088, 2678784, 2580480, 2482176, 2383872, 2285568, 2187264, 3072000, 2146435072, 2146435072, 2146435072, 2146435072, 2146435072, 2146435072, 2146435072, 2146435072, 2146435072, 2146435072, 2146435072, 2146435072, 2146435072, 2146435072, 2146435072, 2146435072, 2146435072, 2146435072, 2146435072, 2146435072
    .long 1991040, 2089344, 2974080, 2875776, 2777472, 2679168, 2580864, 2482560, 2384256, 2285952, 2187648, 3072384, 2146435072, 2146435072, 2146435072, 2146435072, 2146435072, 2146435072, 2146435072, 2146435072, 2146435072, 2146435072, 2146435072, 2146435072, 2146435072, 2146435072, 2146435072, 2146435072, 2146435072, 2146435072, 2146435072, 2146435072
    .long 1991424, 2089728, 2974464, 2876160, 2777856, 2679552, 2581248, 2482944, 2384640, 2286336, 2188032, 3072768, 2146435072, 2146435072, 2146435072, 2146435072, 2146435072, 2146435072, 2146435072, 2146435072, 2146435072, 2146435072, 2146435072, 2146435072, 2146435072, 2146435072, 2146435072, 2146435072, 2146435072, 2146435072, 2146435072, 2146435072
    .long 1991808, 2090112, 2974848, 2876544, 2778240, 2679936, 2581632, 2483328, 2385024, 2286720, 2188416, 3073152, 2146435072, 2146435072, 2146435072, 2146435072, 2146435072, 2146435072, 2146435072, 2146435072, 2146435072, 2146435072, 2146435072, 2146435072, 2146435072, 2146435072, 2146435072, 2146435072, 2146435072, 2146435072, 2146435072, 2146435072
    .long 1992192, 2090496, 2975232, 2876928, 2778624, 2680320, 2582016, 2483712, 2385408, 2287104, 2188800, 3073536, 2146435072, 2146435072, 2146435072, 2146435072, 2146435072, 2146435072, 2146435072, 2146435072, 2146435072, 2146435072, 2146435072, 2146435072, 2146435072, 2146435072, 2146435072, 2146435072, 2146435072, 2146435072, 2146435072, 2146435072
    .long 1992576, 2090880, 2975616, 2877312, 2779008, 2680704, 2582400, 2484096, 2385792, 2287488, 2189184, 3073920, 2146435072, 2146435072, 2146435072, 2146435072, 2146435072, 2146435072, 2146435072, 2146435072, 2146435072, 2146435072, 2146435072, 2146435072, 2146435072, 2146435072, 2146435072, 2146435072, 2146435072, 2146435072, 2146435072, 2146435072
    .long 1992960, 2091264, 2976000, 2877696, 2779392, 2681088, 2582784, 2484480, 2386176, 2287872, 2189568, 3074304, 2146435072, 2146435072, 2146435072, 2146435072, 2146435072, 2146435072, 2146435072, 2146435072, 2146435072, 2146435072, 2146435072, 2146435072, 2146435072, 2146435072, 2146435072, 2146435072, 2146435072, 2146435072, 2146435072, 2146435072
    .long 1993344, 2091648, 2976384, 2878080, 2779776, 2681472, 2583168, 2484864, 2386560, 2288256, 2189952, 3074688, 2146435072, 2146435072, 2146435072, 2146435072, 2146435072, 2146435072, 2146435072, 2146435072, 2146435072, 2146435072, 2146435072, 2146435072, 2146435072, 2146435072, 2146435072, 2146435072, 2146435072, 2146435072, 2146435072, 2146435072
    .long 5962752, 6061056, 6945792, 6847488, 6749184, 6650880, 6552576, 6454272, 6355968, 6257664, 6159360, 7044096, 2146435072, 2146435072, 2146435072, 2146435072, 2146435072, 2146435072, 2146435072, 2146435072, 2146435072, 2146435072, 2146435072, 2146435072, 2146435072, 2146435072, 2146435072, 2146435072, 2146435072, 2146435072, 2146435072, 2146435072
    .long 5963136, 6061440, 6946176, 6847872, 6749568, 6651264, 6552960, 6454656, 6356352, 6258048, 6159744, 7044480, 2146435072, 2146435072, 2146435072, 2146435072, 2146435072, 2146435072, 2146435072, 2146435072, 2146435072, 2146435072, 2146435072, 2146435072, 2146435072, 2146435072, 2146435072, 2146435072, 2146435072, 2146435072, 2146435072, 2146435072
    .long 5963520, 6061824, 6946560, 6848256, 6749952, 6651648, 6553344, 6455040, 6356736, 6258432, 6160128, 7044864, 2146435072, 2146435072, 2146435072, 2146435072, 2146435072, 2146435072, 2146435072, 2146435072, 2146435072, 2146435072, 2146435072, 2146435072, 2146435072, 2146435072, 2146435072, 2146435072, 2146435072, 2146435072, 2146435072, 2146435072
    .long 5963904, 6062208, 6946944, 6848640, 6750336, 6652032, 6553728, 6455424, 6357120, 6258816, 6160512, 7045248, 2146435072, 2146435072, 2146435072, 2146435072, 2146435072, 2146435072, 2146435072, 2146435072, 2146435072, 2146435072, 2146435072, 2146435072, 2146435072, 2146435072, 2146435072, 2146435072, 2146435072, 2146435072, 2146435072, 2146435072
    .long 5964288, 6062592, 6947328, 6849024, 6750720, 6652416, 6554112, 6455808, 6357504, 6259200, 6160896, 7045632, 2146435072, 2146435072, 2146435072, 2146435072, 2146435072, 2146435072, 2146435072, 2146435072, 2146435072, 2146435072, 2146435072, 2146435072, 2146435072, 2146435072, 2146435072, 2146435072, 2146435072, 2146435072, 2146435072, 2146435072
    .long 5964672, 6062976, 6947712, 6849408, 6751104, 6652800, 6554496, 6456192, 6357888, 6259584, 6161280, 7046016, 2146435072, 2146435072, 2146435072, 2146435072, 2146435072, 2146435072, 2146435072, 2146435072, 2146435072, 2146435072, 2146435072, 2146435072, 2146435072, 2146435072, 2146435072, 2146435072, 2146435072, 2146435072, 2146435072, 2146435072
    .long 5965056, 6063360, 6948096, 6849792, 6751488, 6653184, 6554880, 6456576, 6358272, 6259968, 6161664, 7046400, 2146435072, 2146435072, 2146435072, 2146435072, 2146435072, 2146435072, 2146435072, 2146435072, 2146435072, 2146435072, 2146435072, 2146435072, 2146435072, 2146435072, 2146435072, 2146435072, 2146435072, 2146435072, 2146435072, 2146435072
    .long 5965440, 6063744, 6948480, 6850176, 6751872, 6653568, 6555264, 6456960, 6358656, 6260352, 6162048, 7046784, 2146435072, 2146435072, 2146435072, 2146435072, 2146435072, 2146435072, 2146435072, 2146435072, 2146435072, 2146435072, 2146435072, 2146435072, 2146435072, 2146435072, 2146435072, 2146435072, 2146435072, 2146435072, 2146435072, 2146435072
    .long 1554432, 1652736, 1751040, 1849344, 0, 98304, 196608, 294912, 2146435072, 2146435072, 2146435072, 2146435072, 2146435072, 2146435072, 2146435072, 2146435072, 2146435072, 2146435072, 2146435072, 2146435072, 2146435072, 2146435072, 2146435072, 2146435072, 2146435072, 2146435072, 2146435072, 2146435072, 2146435072, 2146435072, 2146435072, 2146435072
    .long 1554816, 1653120, 1751424, 1849728, 384, 98688, 196992, 295296, 2146435072, 2146435072, 2146435072, 2146435072, 2146435072, 2146435072, 2146435072, 2146435072, 2146435072, 2146435072, 2146435072, 2146435072, 2146435072, 2146435072, 2146435072, 2146435072, 2146435072, 2146435072, 2146435072, 2146435072, 2146435072, 2146435072, 2146435072, 2146435072
    .long 1555200, 1653504, 1751808, 1850112, 768, 99072, 197376, 295680, 2146435072, 2146435072, 2146435072, 2146435072, 2146435072, 2146435072, 2146435072, 2146435072, 2146435072, 2146435072, 2146435072, 2146435072, 2146435072, 2146435072, 2146435072, 2146435072, 2146435072, 2146435072, 2146435072, 2146435072, 2146435072, 2146435072, 2146435072, 2146435072
    .long 1555584, 1653888, 1752192, 1850496, 1152, 99456, 197760, 296064, 2146435072, 2146435072, 2146435072, 2146435072, 2146435072, 2146435072, 2146435072, 2146435072, 2146435072, 2146435072, 2146435072, 2146435072, 2146435072, 2146435072, 2146435072, 2146435072, 2146435072, 2146435072, 2146435072, 2146435072, 2146435072, 2146435072, 2146435072, 2146435072
    .long 1555968, 1654272, 1752576, 1850880, 1536, 99840, 198144, 296448, 2146435072, 2146435072, 2146435072, 2146435072, 2146435072, 2146435072, 2146435072, 2146435072, 2146435072, 2146435072, 2146435072, 2146435072, 2146435072, 2146435072, 2146435072, 2146435072, 2146435072, 2146435072, 2146435072, 2146435072, 2146435072, 2146435072, 2146435072, 2146435072
    .long 1556352, 1654656, 1752960, 1851264, 1920, 100224, 198528, 296832, 2146435072, 2146435072, 2146435072, 2146435072, 2146435072, 2146435072, 2146435072, 2146435072, 2146435072, 2146435072, 2146435072, 2146435072, 2146435072, 2146435072, 2146435072, 2146435072, 2146435072, 2146435072, 2146435072, 2146435072, 2146435072, 2146435072, 2146435072, 2146435072
    .long 1556736, 1655040, 1753344, 1851648, 2304, 100608, 198912, 297216, 2146435072, 2146435072, 2146435072, 2146435072, 2146435072, 2146435072, 2146435072, 2146435072, 2146435072, 2146435072, 2146435072, 2146435072, 2146435072, 2146435072, 2146435072, 2146435072, 2146435072, 2146435072, 2146435072, 2146435072, 2146435072, 2146435072, 2146435072, 2146435072
    .long 1557120, 1655424, 1753728, 1852032, 2688, 100992, 199296, 297600, 2146435072, 2146435072, 2146435072, 2146435072, 2146435072, 2146435072, 2146435072, 2146435072, 2146435072, 2146435072, 2146435072, 2146435072, 2146435072, 2146435072, 2146435072, 2146435072, 2146435072, 2146435072, 2146435072, 2146435072, 2146435072, 2146435072, 2146435072, 2146435072
    .long 0, 98304, 393216, 294912, 196608, 491520, 3406848, 3505152, 2146435072, 2146435072, 2146435072, 2146435072, 2146435072, 2146435072, 2146435072, 2146435072, 2146435072, 2146435072, 2146435072, 2146435072, 2146435072, 2146435072, 2146435072, 2146435072, 2146435072, 2146435072, 2146435072, 2146435072, 2146435072, 2146435072, 2146435072, 2146435072
    .long 384, 98688, 393600, 295296, 196992, 491904, 3407232, 3505536, 2146435072, 2146435072, 2146435072, 2146435072, 2146435072, 2146435072, 2146435072, 2146435072, 2146435072, 2146435072, 2146435072, 2146435072, 2146435072, 2146435072, 2146435072, 2146435072, 2146435072, 2146435072, 2146435072, 2146435072, 2146435072, 2146435072, 2146435072, 2146435072
    .long 768, 99072, 393984, 295680, 197376, 492288, 3407616, 3505920, 2146435072, 2146435072, 2146435072, 2146435072, 2146435072, 2146435072, 2146435072, 2146435072, 2146435072, 2146435072, 2146435072, 2146435072, 2146435072, 2146435072, 2146435072, 2146435072, 2146435072, 2146435072, 2146435072, 2146435072, 2146435072, 2146435072, 2146435072, 2146435072
    .long 1152, 99456, 394368, 296064, 197760, 492672, 3408000, 3506304, 2146435072, 2146435072, 2146435072, 2146435072, 2146435072, 2146435072, 2146435072, 2146435072, 2146435072, 2146435072, 2146435072, 2146435072, 2146435072, 2146435072, 2146435072, 2146435072, 2146435072, 2146435072, 2146435072, 2146435072, 2146435072, 2146435072, 2146435072, 2146435072
    .long 1536, 99840, 394752, 296448, 198144, 493056, 3408384, 3506688, 2146435072, 2146435072, 2146435072, 2146435072, 2146435072, 2146435072, 2146435072, 2146435072, 2146435072, 2146435072, 2146435072, 2146435072, 2146435072, 2146435072, 2146435072, 2146435072, 2146435072, 2146435072, 2146435072, 2146435072, 2146435072, 2146435072, 2146435072, 2146435072
    .long 1920, 100224, 395136, 296832, 198528, 493440, 3408768, 3507072, 2146435072, 2146435072, 2146435072, 2146435072, 2146435072, 2146435072, 2146435072, 2146435072, 2146435072, 2146435072, 2146435072, 2146435072, 2146435072, 2146435072, 2146435072, 2146435072, 2146435072, 2146435072, 2146435072, 2146435072, 2146435072, 2146435072, 2146435072, 2146435072
    .long 2304, 100608, 395520, 297216, 198912, 493824, 3409152, 3507456, 2146435072, 2146435072, 2146435072, 2146435072, 2146435072, 2146435072, 2146435072, 2146435072, 2146435072, 2146435072, 2146435072, 2146435072, 2146435072, 2146435072, 2146435072, 2146435072, 2146435072, 2146435072, 2146435072, 2146435072, 2146435072, 2146435072, 2146435072, 2146435072
    .long 2688, 100992, 395904, 297600, 199296, 494208, 3409536, 3507840, 2146435072, 2146435072, 2146435072, 2146435072, 2146435072, 2146435072, 2146435072, 2146435072, 2146435072, 2146435072, 2146435072, 2146435072, 2146435072, 2146435072, 2146435072, 2146435072, 2146435072, 2146435072, 2146435072, 2146435072, 2146435072, 2146435072, 2146435072, 2146435072
    .long 1990656, 2088960, 2383872, 2285568, 2187264, 2482176, 0, 98304, 2146435072, 2146435072, 2146435072, 2146435072, 2146435072, 2146435072, 2146435072, 2146435072, 2146435072, 2146435072, 2146435072, 2146435072, 2146435072, 2146435072, 2146435072, 2146435072, 2146435072, 2146435072, 2146435072, 2146435072, 2146435072, 2146435072, 2146435072, 2146435072
    .long 1991040, 2089344, 2384256, 2285952, 2187648, 2482560, 384, 98688, 2146435072, 2146435072, 2146435072, 2146435072, 2146435072, 2146435072, 2146435072, 2146435072, 2146435072, 2146435072, 2146435072, 2146435072, 2146435072, 2146435072, 2146435072, 2146435072, 2146435072, 2146435072, 2146435072, 2146435072, 2146435072, 2146435072, 2146435072, 2146435072
    .long 1991424, 2089728, 2384640, 2286336, 2188032, 2482944, 768, 99072, 2146435072, 2146435072, 2146435072, 2146435072, 2146435072, 2146435072, 2146435072, 2146435072, 2146435072, 2146435072, 2146435072, 2146435072, 2146435072, 2146435072, 2146435072, 2146435072, 2146435072, 2146435072, 2146435072, 2146435072, 2146435072, 2146435072, 2146435072, 2146435072
    .long 1991808, 2090112, 2385024, 2286720, 2188416, 2483328, 1152, 99456, 2146435072, 2146435072, 2146435072, 2146435072, 2146435072, 2146435072, 2146435072, 2146435072, 2146435072, 2146435072, 2146435072, 2146435072, 2146435072, 2146435072, 2146435072, 2146435072, 2146435072, 2146435072, 2146435072, 2146435072, 2146435072, 2146435072, 2146435072, 2146435072
    .long 1992192, 2090496, 2385408, 2287104, 2188800, 2483712, 1536, 99840, 2146435072, 2146435072, 2146435072, 2146435072, 2146435072, 2146435072, 2146435072, 2146435072, 2146435072, 2146435072, 2146435072, 2146435072, 2146435072, 2146435072, 2146435072, 2146435072, 2146435072, 2146435072, 2146435072, 2146435072, 2146435072, 2146435072, 2146435072, 2146435072
    .long 1992576, 2090880, 2385792, 2287488, 2189184, 2484096, 1920, 100224, 2146435072, 2146435072, 2146435072, 2146435072, 2146435072, 2146435072, 2146435072, 2146435072, 2146435072, 2146435072, 2146435072, 2146435072, 2146435072, 2146435072, 2146435072, 2146435072, 2146435072, 2146435072, 2146435072, 2146435072, 2146435072, 2146435072, 2146435072, 2146435072
    .long 1992960, 2091264, 2386176, 2287872, 2189568, 2484480, 2304, 100608, 2146435072, 2146435072, 2146435072, 2146435072, 2146435072, 2146435072, 2146435072, 2146435072, 2146435072, 2146435072, 2146435072, 2146435072, 2146435072, 2146435072, 2146435072, 2146435072, 2146435072, 2146435072, 2146435072, 2146435072, 2146435072, 2146435072, 2146435072, 2146435072
    .long 1993344, 2091648, 2386560, 2288256, 2189952, 2484864, 2688, 100992, 2146435072, 2146435072, 2146435072, 2146435072, 2146435072, 2146435072, 2146435072, 2146435072, 2146435072, 2146435072, 2146435072, 2146435072, 2146435072, 2146435072, 2146435072, 2146435072, 2146435072, 2146435072, 2146435072, 2146435072, 2146435072, 2146435072, 2146435072, 2146435072
    .long 0, 98304, 786432, 688128, 589824, 491520, 393216, 294912, 196608, 884736, 2146435072, 2146435072, 2146435072, 2146435072, 2146435072, 2146435072, 2146435072, 2146435072, 2146435072, 2146435072, 2146435072, 2146435072, 2146435072, 2146435072, 2146435072, 2146435072, 2146435072, 2146435072, 2146435072, 2146435072, 2146435072, 2146435072
    .long 384, 98688, 786816, 688512, 590208, 491904, 393600, 295296, 196992, 885120, 2146435072, 2146435072, 2146435072, 2146435072, 2146435072, 2146435072, 2146435072, 2146435072, 2146435072, 2146435072, 2146435072, 2146435072, 2146435072, 2146435072, 2146435072, 2146435072, 2146435072, 2146435072, 2146435072, 2146435072, 2146435072, 2146435072
    .long 768, 99072, 787200, 688896, 590592, 492288, 393984, 295680, 197376, 885504, 2146435072, 2146435072, 2146435072, 2146435072, 2146435072, 2146435072, 2146435072, 2146435072, 2146435072, 2146435072, 2146435072, 2146435072, 2146435072, 2146435072, 2146435072, 2146435072, 2146435072, 2146435072, 2146435072, 2146435072, 2146435072, 2146435072
    .long 1152, 99456, 787584, 689280, 590976, 492672, 394368, 296064, 197760, 885888, 2146435072, 2146435072, 2146435072, 2146435072, 2146435072, 2146435072, 2146435072, 2146435072, 2146435072, 2146435072, 2146435072, 2146435072, 2146435072, 2146435072, 2146435072, 2146435072, 2146435072, 2146435072, 2146435072, 2146435072, 2146435072, 2146435072
    .long 1536, 99840, 787968, 689664, 591360, 493056, 394752, 296448, 198144, 886272, 2146435072, 2146435072, 2146435072, 2146435072, 2146435072, 2146435072, 2146435072, 2146435072, 2146435072, 2146435072, 2146435072, 2146435072, 2146435072, 2146435072, 2146435072, 2146435072, 2146435072, 2146435072, 2146435072, 2146435072, 2146435072, 2146435072
    .long 1920, 100224, 788352, 690048, 591744, 493440, 395136, 296832, 198528, 886656, 2146435072, 2146435072, 2146435072, 2146435072, 2146435072, 2146435072, 2146435072, 2146435072, 2146435072, 2146435072, 2146435072, 2146435072, 2146435072, 2146435072, 2146435072, 2146435072, 2146435072, 2146435072, 2146435072, 2146435072, 2146435072, 2146435072
    .long 2304, 100608, 788736, 690432, 592128, 493824, 395520, 297216, 198912, 887040, 2146435072, 2146435072, 2146435072, 2146435072, 2146435072, 2146435072, 2146435072, 2146435072, 2146435072, 2146435072, 2146435072, 2146435072, 2146435072, 2146435072, 2146435072, 2146435072, 2146435072, 2146435072, 2146435072, 2146435072, 2146435072, 2146435072
    .long 2688, 100992, 789120, 690816, 592512, 494208, 395904, 297600, 199296, 887424, 2146435072, 2146435072, 2146435072, 2146435072, 2146435072, 2146435072, 2146435072, 2146435072, 2146435072, 2146435072, 2146435072, 2146435072, 2146435072, 2146435072, 2146435072, 2146435072, 2146435072, 2146435072, 2146435072, 2146435072, 2146435072, 2146435072
    .long 1990656, 2088960, 2777088, 2678784, 2580480, 2482176, 2383872, 2285568, 2187264, 2875392, 2146435072, 2146435072, 2146435072, 2146435072, 2146435072, 2146435072, 2146435072, 2146435072, 2146435072, 2146435072, 2146435072, 2146435072, 2146435072, 2146435072, 2146435072, 2146435072, 2146435072, 2146435072, 2146435072, 2146435072, 2146435072, 2146435072
    .long 1991040, 2089344, 2777472, 2679168, 2580864, 2482560, 2384256, 2285952, 2187648, 2875776, 2146435072, 2146435072, 2146435072, 2146435072, 2146435072, 2146435072, 2146435072, 2146435072, 2146435072, 2146435072, 2146435072, 2146435072, 2146435072, 2146435072, 2146435072, 2146435072, 2146435072, 2146435072, 2146435072, 2146435072, 2146435072, 2146435072
    .long 1991424, 2089728, 2777856, 2679552, 2581248, 2482944, 2384640, 2286336, 2188032, 2876160, 2146435072, 2146435072, 2146435072, 2146435072, 2146435072, 2146435072, 2146435072, 2146435072, 2146435072, 2146435072, 2146435072, 2146435072, 2146435072, 2146435072, 2146435072, 2146435072, 2146435072, 2146435072, 2146435072, 2146435072, 2146435072, 2146435072
    .long 1991808, 2090112, 2778240, 2679936, 2581632, 2483328, 2385024, 2286720, 2188416, 2876544, 2146435072, 2146435072, 2146435072, 2146435072, 2146435072, 2146435072, 2146435072, 2146435072, 2146435072, 2146435072, 2146435072, 2146435072, 2146435072, 2146435072, 2146435072, 2146435072, 2146435072, 2146435072, 2146435072, 2146435072, 2146435072, 2146435072
    .long 1992192, 2090496, 2778624, 2680320, 2582016, 2483712, 2385408, 2287104, 2188800, 2876928, 2146435072, 2146435072, 2146435072, 2146435072, 2146435072, 2146435072, 2146435072, 2146435072, 2146435072, 2146435072, 2146435072, 2146435072, 2146435072, 2146435072, 2146435072, 2146435072, 2146435072, 2146435072, 2146435072, 2146435072, 2146435072, 2146435072
    .long 1992576, 2090880, 2779008, 2680704, 2582400, 2484096, 2385792, 2287488, 2189184, 2877312, 2146435072, 2146435072, 2146435072, 2146435072, 2146435072, 2146435072, 2146435072, 2146435072, 2146435072, 2146435072, 2146435072, 2146435072, 2146435072, 2146435072, 2146435072, 2146435072, 2146435072, 2146435072, 2146435072, 2146435072, 2146435072, 2146435072
    .long 1992960, 2091264, 2779392, 2681088, 2582784, 2484480, 2386176, 2287872, 2189568, 2877696, 2146435072, 2146435072, 2146435072, 2146435072, 2146435072, 2146435072, 2146435072, 2146435072, 2146435072, 2146435072, 2146435072, 2146435072, 2146435072, 2146435072, 2146435072, 2146435072, 2146435072, 2146435072, 2146435072, 2146435072, 2146435072, 2146435072
    .long 1993344, 2091648, 2779776, 2681472, 2583168, 2484864, 2386560, 2288256, 2189952, 2878080, 2146435072, 2146435072, 2146435072, 2146435072, 2146435072, 2146435072, 2146435072, 2146435072, 2146435072, 2146435072, 2146435072, 2146435072, 2146435072, 2146435072, 2146435072, 2146435072, 2146435072, 2146435072, 2146435072, 2146435072, 2146435072, 2146435072
    .long 3406848, 3505152, 4193280, 4094976, 3996672, 3898368, 3800064, 3701760, 3603456, 4291584, 2146435072, 2146435072, 2146435072, 2146435072, 2146435072, 2146435072, 2146435072, 2146435072, 2146435072, 2146435072, 2146435072, 2146435072, 2146435072, 2146435072, 2146435072, 2146435072, 2146435072, 2146435072, 2146435072, 2146435072, 2146435072, 2146435072
    .long 3407232, 3505536, 4193664, 4095360, 3997056, 3898752, 3800448, 3702144, 3603840, 4291968, 2146435072, 2146435072, 2146435072, 2146435072, 2146435072, 2146435072, 2146435072, 2146435072, 2146435072, 2146435072, 2146435072, 2146435072, 2146435072, 2146435072, 2146435072, 2146435072, 2146435072, 2146435072, 2146435072, 2146435072, 2146435072, 2146435072
    .long 3407616, 3505920, 4194048, 4095744, 3997440, 3899136, 3800832, 3702528, 3604224, 4292352, 2146435072, 2146435072, 2146435072, 2146435072, 2146435072, 2146435072, 2146435072, 2146435072, 2146435072, 2146435072, 2146435072, 2146435072, 2146435072, 2146435072, 2146435072, 2146435072, 2146435072, 2146435072, 2146435072, 2146435072, 2146435072, 2146435072
    .long 3408000, 3506304, 4194432, 4096128, 3997824, 3899520, 3801216, 3702912, 3604608, 4292736, 2146435072, 2146435072, 2146435072, 2146435072, 2146435072, 2146435072, 2146435072, 2146435072, 2146435072, 2146435072, 2146435072, 2146435072, 2146435072, 2146435072, 2146435072, 2146435072, 2146435072, 2146435072, 2146435072, 2146435072, 2146435072, 2146435072
    .long 3408384, 3506688, 4194816, 4096512, 3998208, 3899904, 3801600, 3703296, 3604992, 4293120, 2146435072, 2146435072, 2146435072, 2146435072, 2146435072, 2146435072, 2146435072, 2146435072, 2146435072, 2146435072, 2146435072, 2146435072, 2146435072, 2146435072, 2146435072, 2146435072, 2146435072, 2146435072, 2146435072, 2146435072, 2146435072, 2146435072
    .long 3408768, 3507072, 4195200, 4096896, 3998592, 3900288, 3801984, 3703680, 3605376, 4293504, 2146435072, 2146435072, 2146435072, 2146435072, 2146435072, 2146435072, 2146435072, 2146435072, 2146435072, 2146435072, 2146435072, 2146435072, 2146435072, 2146435072, 2146435072, 2146435072, 2146435072, 2146435072, 2146435072, 2146435072, 2146435072, 2146435072
    .long 3409152, 3507456, 4195584, 4097280, 3998976, 3900672, 3802368, 3704064, 3605760, 4293888, 2146435072, 2146435072, 2146435072, 2146435072, 2146435072, 2146435072, 2146435072, 2146435072, 2146435072, 2146435072, 2146435072, 2146435072, 2146435072, 2146435072, 2146435072, 2146435072, 2146435072, 2146435072, 2146435072, 2146435072, 2146435072, 2146435072
    .long 3409536, 3507840, 4195968, 4097664, 3999360, 3901056, 3802752, 3704448, 3606144, 4294272, 2146435072, 2146435072, 2146435072, 2146435072, 2146435072, 2146435072, 2146435072, 2146435072, 2146435072, 2146435072, 2146435072, 2146435072, 2146435072, 2146435072, 2146435072, 2146435072, 2146435072, 2146435072, 2146435072, 2146435072, 2146435072, 2146435072
    .long 5050368, 5148672, 5836800, 5738496, 5640192, 5541888, 5443584, 5345280, 5246976, 5935104, 2146435072, 2146435072, 2146435072, 2146435072, 2146435072, 2146435072, 2146435072, 2146435072, 2146435072, 2146435072, 2146435072, 2146435072, 2146435072, 2146435072, 2146435072, 2146435072, 2146435072, 2146435072, 2146435072, 2146435072, 2146435072, 2146435072
    .long 5050752, 5149056, 5837184, 5738880, 5640576, 5542272, 5443968, 5345664, 5247360, 5935488, 2146435072, 2146435072, 2146435072, 2146435072, 2146435072, 2146435072, 2146435072, 2146435072, 2146435072, 2146435072, 2146435072, 2146435072, 2146435072, 2146435072, 2146435072, 2146435072, 2146435072, 2146435072, 2146435072, 2146435072, 2146435072, 2146435072
    .long 5051136, 5149440, 5837568, 5739264, 5640960, 5542656, 5444352, 5346048, 5247744, 5935872, 2146435072, 2146435072, 2146435072, 2146435072, 2146435072, 2146435072, 2146435072, 2146435072, 2146435072, 2146435072, 2146435072, 2146435072, 2146435072, 2146435072, 2146435072, 2146435072, 2146435072, 2146435072, 2146435072, 2146435072, 2146435072, 2146435072
    .long 5051520, 5149824, 5837952, 5739648, 5641344, 5543040, 5444736, 5346432, 5248128, 5936256, 2146435072, 2146435072, 2146435072, 2146435072, 2146435072, 2146435072, 2146435072, 2146435072, 2146435072, 2146435072, 2146435072, 2146435072, 2146435072, 2146435072, 2146435072, 2146435072, 2146435072, 2146435072, 2146435072, 2146435072, 2146435072, 2146435072
    .long 5051904, 5150208, 5838336, 5740032, 5641728, 5543424, 5445120, 5346816, 5248512, 5936640, 2146435072, 2146435072, 2146435072, 2146435072, 2146435072, 2146435072, 2146435072, 2146435072, 2146435072, 2146435072, 2146435072, 2146435072, 2146435072, 2146435072, 2146435072, 2146435072, 2146435072, 2146435072, 2146435072, 2146435072, 2146435072, 2146435072
    .long 5052288, 5150592, 5838720, 5740416, 5642112, 5543808, 5445504, 5347200, 5248896, 5937024, 2146435072, 2146435072, 2146435072, 2146435072, 2146435072, 2146435072, 2146435072, 2146435072, 2146435072, 2146435072, 2146435072, 2146435072, 2146435072, 2146435072, 2146435072, 2146435072, 2146435072, 2146435072, 2146435072, 2146435072, 2146435072, 2146435072
    .long 5052672, 5150976, 5839104, 5740800, 5642496, 5544192, 5445888, 5347584, 5249280, 5937408, 2146435072, 2146435072, 2146435072, 2146435072, 2146435072, 2146435072, 2146435072, 2146435072, 2146435072, 2146435072, 2146435072, 2146435072, 2146435072, 2146435072, 2146435072, 2146435072, 2146435072, 2146435072, 2146435072, 2146435072, 2146435072, 2146435072
    .long 5053056, 5151360, 5839488, 5741184, 5642880, 5544576, 5446272, 5347968, 5249664, 5937792, 2146435072, 2146435072, 2146435072, 2146435072, 2146435072, 2146435072, 2146435072, 2146435072, 2146435072, 2146435072, 2146435072, 2146435072, 2146435072, 2146435072, 2146435072, 2146435072, 2146435072, 2146435072, 2146435072, 2146435072, 2146435072, 2146435072
    .long 5962752, 6061056, 6749184, 6650880, 6552576, 6454272, 6355968, 6257664, 6159360, 6847488, 2146435072, 2146435072, 2146435072, 2146435072, 2146435072, 2146435072, 2146435072, 2146435072, 2146435072, 2146435072, 2146435072, 2146435072, 2146435072, 2146435072, 2146435072, 2146435072, 2146435072, 2146435072, 2146435072, 2146435072, 2146435072, 2146435072
    .long 5963136, 6061440, 6749568, 6651264, 6552960, 6454656, 6356352, 6258048, 6159744, 6847872, 2146435072, 2146435072, 2146435072, 2146435072, 2146435072, 2146435072, 2146435072, 2146435072, 2146435072, 2146435072, 2146435072, 2146435072, 2146435072, 2146435072, 2146435072, 2146435072, 2146435072, 2146435072, 2146435072, 2146435072, 2146435072, 2146435072
    .long 5963520, 6061824, 6749952, 6651648, 6553344, 6455040, 6356736, 6258432, 6160128, 6848256, 2146435072, 2146435072, 2146435072, 2146435072, 2146435072, 2146435072, 2146435072, 2146435072, 2146435072, 2146435072, 2146435072, 2146435072, 2146435072, 2146435072, 2146435072, 2146435072, 2146435072, 2146435072, 2146435072, 2146435072, 2146435072, 2146435072
    .long 5963904, 6062208, 6750336, 6652032, 6553728, 6455424, 6357120, 6258816, 6160512, 6848640, 2146435072, 2146435072, 2146435072, 2146435072, 2146435072, 2146435072, 2146435072, 2146435072, 2146435072, 2146435072, 2146435072, 2146435072, 2146435072, 2146435072, 2146435072, 2146435072, 2146435072, 2146435072, 2146435072, 2146435072, 2146435072, 2146435072
    .long 5964288, 6062592, 6750720, 6652416, 6554112, 6455808, 6357504, 6259200, 6160896, 6849024, 2146435072, 2146435072, 2146435072, 2146435072, 2146435072, 2146435072, 2146435072, 2146435072, 2146435072, 2146435072, 2146435072, 2146435072, 2146435072, 2146435072, 2146435072, 2146435072, 2146435072, 2146435072, 2146435072, 2146435072, 2146435072, 2146435072
    .long 5964672, 6062976, 6751104, 6652800, 6554496, 6456192, 6357888, 6259584, 6161280, 6849408, 2146435072, 2146435072, 2146435072, 2146435072, 2146435072, 2146435072, 2146435072, 2146435072, 2146435072, 2146435072, 2146435072, 2146435072, 2146435072, 2146435072, 2146435072, 2146435072, 2146435072, 2146435072, 2146435072, 2146435072, 2146435072, 2146435072
    .long 5965056, 6063360, 6751488, 6653184, 6554880, 6456576, 6358272, 6259968, 6161664, 6849792, 2146435072, 2146435072, 2146435072, 2146435072, 2146435072, 2146435072, 2146435072, 2146435072, 2146435072, 2146435072, 2146435072, 2146435072, 2146435072, 2146435072, 2146435072, 2146435072, 2146435072, 2146435072, 2146435072, 2146435072, 2146435072, 2146435072
    .long 5965440, 6063744, 6751872, 6653568, 6555264, 6456960, 6358656, 6260352, 6162048, 6850176, 2146435072, 2146435072, 2146435072, 2146435072, 2146435072, 2146435072, 2146435072, 2146435072, 2146435072, 2146435072, 2146435072, 2146435072, 2146435072, 2146435072, 2146435072, 2146435072, 2146435072, 2146435072, 2146435072, 2146435072, 2146435072, 2146435072
    .long 1990656, 2088960, 2187264, 2285568, 4349952, 4448256, 4546560, 4644864, 2146435072, 2146435072, 2146435072, 2146435072, 2146435072, 2146435072, 2146435072, 2146435072, 2146435072, 2146435072, 2146435072, 2146435072, 2146435072, 2146435072, 2146435072, 2146435072, 2146435072, 2146435072, 2146435072, 2146435072, 2146435072, 2146435072, 2146435072, 2146435072
    .long 1991040, 2089344, 2187648, 2285952, 4350336, 4448640, 4546944, 4645248, 2146435072, 2146435072, 2146435072, 2146435072, 2146435072, 2146435072, 2146435072, 2146435072, 2146435072, 2146435072, 2146435072, 2146435072, 2146435072, 2146435072, 2146435072, 2146435072, 2146435072, 2146435072, 2146435072, 2146435072, 2146435072, 2146435072, 2146435072, 2146435072
    .long 1991424, 2089728, 2188032, 2286336, 4350720, 4449024, 4547328, 4645632, 2146435072, 2146435072, 2146435072, 2146435072, 2146435072, 2146435072, 2146435072, 2146435072, 2146435072, 2146435072, 2146435072, 2146435072, 2146435072, 2146435072, 2146435072, 2146435072, 2146435072, 2146435072, 2146435072, 2146435072, 2146435072, 2146435072, 2146435072, 2146435072
    .long 1991808, 2090112, 2188416, 2286720, 4351104, 4449408, 4547712, 4646016, 2146435072, 2146435072, 2146435072, 2146435072, 2146435072, 2146435072, 2146435072, 2146435072, 2146435072, 2146435072, 2146435072, 2146435072, 2146435072, 2146435072, 2146435072, 2146435072, 2146435072, 2146435072, 2146435072, 2146435072, 2146435072, 2146435072, 2146435072, 2146435072
    .long 1992192, 2090496, 2188800, 2287104, 4351488, 4449792, 4548096, 4646400, 2146435072, 2146435072, 2146435072, 2146435072, 2146435072, 2146435072, 2146435072, 2146435072, 2146435072, 2146435072, 2146435072, 2146435072, 2146435072, 2146435072, 2146435072, 2146435072, 2146435072, 2146435072, 2146435072, 2146435072, 2146435072, 2146435072, 2146435072, 2146435072
    .long 1992576, 2090880, 2189184, 2287488, 4351872, 4450176, 4548480, 4646784, 2146435072, 2146435072, 2146435072, 2146435072, 2146435072, 2146435072, 2146435072, 2146435072, 2146435072, 2146435072, 2146435072, 2146435072, 2146435072, 2146435072, 2146435072, 2146435072, 2146435072, 2146435072, 2146435072, 2146435072, 2146435072, 2146435072, 2146435072, 2146435072
    .long 1992960, 2091264, 2189568, 2287872, 4352256, 4450560, 4548864, 4647168, 2146435072, 2146435072, 2146435072, 2146435072, 2146435072, 2146435072, 2146435072, 2146435072, 2146435072, 2146435072, 2146435072, 2146435072, 2146435072, 2146435072, 2146435072, 2146435072, 2146435072, 2146435072, 2146435072, 2146435072, 2146435072, 2146435072, 2146435072, 2146435072
    .long 1993344, 2091648, 2189952, 2288256, 4352640, 4450944, 4549248, 4647552, 2146435072, 2146435072, 2146435072, 2146435072, 2146435072, 2146435072, 2146435072, 2146435072, 2146435072, 2146435072, 2146435072, 2146435072, 2146435072, 2146435072, 2146435072, 2146435072, 2146435072, 2146435072, 2146435072, 2146435072, 2146435072, 2146435072, 2146435072, 2146435072
    .long 1554432, 1652736, 1947648, 1849344, 1751040, 2045952, 1554432, 1652736, 2146435072, 2146435072, 2146435072, 2146435072, 2146435072, 2146435072, 2146435072, 2146435072, 2146435072, 2146435072, 2146435072, 2146435072, 2146435072, 2146435072, 2146435072, 2146435072, 2146435072, 2146435072, 2146435072, 2146435072, 2146435072, 2146435072, 2146435072, 2146435072
    .long 1554816, 1653120, 1948032, 1849728, 1751424, 2046336, 1554816, 1653120, 2146435072, 2146435072, 2146435072, 2146435072, 2146435072, 2146435072, 2146435072, 2146435072, 2146435072, 2146435072, 2146435072, 2146435072, 2146435072, 2146435072, 2146435072, 2146435072, 2146435072, 2146435072, 2146435072, 2146435072, 2146435072, 2146435072, 2146435072, 2146435072
    .long 1555200, 1653504, 1948416, 1850112, 1751808, 2046720, 1555200, 1653504, 2146435072, 2146435072, 2146435072, 2146435072, 2146435072, 2146435072, 2146435072, 2146435072, 2146435072, 2146435072, 2146435072, 2146435072, 2146435072, 2146435072, 2146435072, 2146435072, 2146435072, 2146435072, 2146435072, 2146435072, 2146435072, 2146435072, 2146435072, 2146435072
    .long 1555584, 1653888, 1948800, 1850496, 1752192, 2047104, 1555584, 1653888, 2146435072, 2146435072, 2146435072, 2146435072, 2146435072, 2146435072, 2146435072, 2146435072, 2146435072, 2146435072, 2146435072, 2146435072, 2146435072, 2146435072, 2146435072, 2146435072, 2146435072, 2146435072, 2146435072, 2146435072, 2146435072, 2146435072, 2146435072, 2146435072
    .long 1555968, 1654272, 1949184, 1850880, 1752576, 2047488, 1555968, 1654272, 2146435072, 2146435072, 2146435072, 2146435072, 2146435072, 2146435072, 2146435072, 2146435072, 2146435072, 2146435072, 2146435072, 2146435072, 2146435072, 2146435072, 2146435072, 2146435072, 2146435072, 2146435072, 2146435072, 2146435072, 2146435072, 2146435072, 2146435072, 2146435072
    .long 1556352, 1654656, 1949568, 1851264, 1752960, 2047872, 1556352, 1654656, 2146435072, 2146435072, 2146435072, 2146435072, 2146435072, 2146435072, 2146435072, 2146435072, 2146435072, 2146435072, 2146435072, 2146435072, 2146435072, 2146435072, 2146435072, 2146435072, 2146435072, 2146435072, 2146435072, 2146435072, 2146435072, 2146435072, 2146435072, 2146435072
    .long 1556736, 1655040, 1949952, 1851648, 1753344, 2048256, 1556736, 1655040, 2146435072, 2146435072, 2146435072, 2146435072, 2146435072, 2146435072, 2146435072, 2146435072, 2146435072, 2146435072, 2146435072, 2146435072, 2146435072, 2146435072, 2146435072, 2146435072, 2146435072, 2146435072, 2146435072, 2146435072, 2146435072, 2146435072, 2146435072, 2146435072
    .long 1557120, 1655424, 1950336, 1852032, 1753728, 2048640, 1557120, 1655424, 2146435072, 2146435072, 2146435072, 2146435072, 2146435072, 2146435072, 2146435072, 2146435072, 2146435072, 2146435072, 2146435072, 2146435072, 2146435072, 2146435072, 2146435072, 2146435072, 2146435072, 2146435072, 2146435072, 2146435072, 2146435072, 2146435072, 2146435072, 2146435072
    .long 4589568, 4687872, 4982784, 4884480, 4786176, 5081088, 1990656, 2088960, 2146435072, 2146435072, 2146435072, 2146435072, 2146435072, 2146435072, 2146435072, 2146435072, 2146435072, 2146435072, 2146435072, 2146435072, 2146435072, 2146435072, 2146435072, 2146435072, 2146435072, 2146435072, 2146435072, 2146435072, 2146435072, 2146435072, 2146435072, 2146435072
    .long 4589952, 4688256, 4983168, 4884864, 4786560, 5081472, 1991040, 2089344, 2146435072, 2146435072, 2146435072, 2146435072, 2146435072, 2146435072, 2146435072, 2146435072, 2146435072, 2146435072, 2146435072, 2146435072, 2146435072, 2146435072, 2146435072, 2146435072, 2146435072, 2146435072, 2146435072, 2146435072, 2146435072, 2146435072, 2146435072, 2146435072
    .long 4590336, 4688640, 4983552, 4885248, 4786944, 5081856, 1991424, 2089728, 2146435072, 2146435072, 2146435072, 2146435072, 2146435072, 2146435072, 2146435072, 2146435072, 2146435072, 2146435072, 2146435072, 2146435072, 2146435072, 2146435072, 2146435072, 2146435072, 2146435072, 2146435072, 2146435072, 2146435072, 2146435072, 2146435072, 2146435072, 2146435072
    .long 4590720, 4689024, 4983936, 4885632, 4787328, 5082240, 1991808, 2090112, 2146435072, 2146435072, 2146435072, 2146435072, 2146435072, 2146435072, 2146435072, 2146435072, 2146435072, 2146435072, 2146435072, 2146435072, 2146435072, 2146435072, 2146435072, 2146435072, 2146435072, 2146435072, 2146435072, 2146435072, 2146435072, 2146435072, 2146435072, 2146435072
    .long 4591104, 4689408, 4984320, 4886016, 4787712, 5082624, 1992192, 2090496, 2146435072, 2146435072, 2146435072, 2146435072, 2146435072, 2146435072, 2146435072, 2146435072, 2146435072, 2146435072, 2146435072, 2146435072, 2146435072, 2146435072, 2146435072, 2146435072, 2146435072, 2146435072, 2146435072, 2146435072, 2146435072, 2146435072, 2146435072, 2146435072
    .long 4591488, 4689792, 4984704, 4886400, 4788096, 5083008, 1992576, 2090880, 2146435072, 2146435072, 2146435072, 2146435072, 2146435072, 2146435072, 2146435072, 2146435072, 2146435072, 2146435072, 2146435072, 2146435072, 2146435072, 2146435072, 2146435072, 2146435072, 2146435072, 2146435072, 2146435072, 2146435072, 2146435072, 2146435072, 2146435072, 2146435072
    .long 4591872, 4690176, 4985088, 4886784, 4788480, 5083392, 1992960, 2091264, 2146435072, 2146435072, 2146435072, 2146435072, 2146435072, 2146435072, 2146435072, 2146435072, 2146435072, 2146435072, 2146435072, 2146435072, 2146435072, 2146435072, 2146435072, 2146435072, 2146435072, 2146435072, 2146435072, 2146435072, 2146435072, 2146435072, 2146435072, 2146435072
    .long 4592256, 4690560, 4985472, 4887168, 4788864, 5083776, 1993344, 2091648, 2146435072, 2146435072, 2146435072, 2146435072, 2146435072, 2146435072, 2146435072, 2146435072, 2146435072, 2146435072, 2146435072, 2146435072, 2146435072, 2146435072, 2146435072, 2146435072, 2146435072, 2146435072, 2146435072, 2146435072, 2146435072, 2146435072, 2146435072, 2146435072
    .long 3406848, 3505152, 3603456, 3701760, 5962752, 6061056, 2146435072, 2146435072, 2146435072, 2146435072, 2146435072, 2146435072, 2146435072, 2146435072, 2146435072, 2146435072, 2146435072, 2146435072, 2146435072, 2146435072, 2146435072, 2146435072, 2146435072, 2146435072, 2146435072, 2146435072, 2146435072, 2146435072, 2146435072, 2146435072, 2146435072, 2146435072
    .long 3407232, 3505536, 3603840, 3702144, 5963136, 6061440, 2146435072, 2146435072, 2146435072, 2146435072, 2146435072, 2146435072, 2146435072, 2146435072, 2146435072, 2146435072, 2146435072, 2146435072, 2146435072, 2146435072, 2146435072, 2146435072, 2146435072, 2146435072, 2146435072, 2146435072, 2146435072, 2146435072, 2146435072, 2146435072, 2146435072, 2146435072
    .long 3407616, 3505920, 3604224, 3702528, 5963520, 6061824, 2146435072, 2146435072, 2146435072, 2146435072, 2146435072, 2146435072, 2146435072, 2146435072, 2146435072, 2146435072, 2146435072, 2146435072, 2146435072, 2146435072, 2146435072, 2146435072, 2146435072, 2146435072, 2146435072, 2146435072, 2146435072, 2146435072, 2146435072, 2146435072, 2146435072, 2146435072
    .long 3408000, 3506304, 3604608, 3702912, 5963904, 6062208, 2146435072, 2146435072, 2146435072, 2146435072, 2146435072, 2146435072, 2146435072, 2146435072, 2146435072, 2146435072, 2146435072, 2146435072, 2146435072, 2146435072, 2146435072, 2146435072, 2146435072, 2146435072, 2146435072, 2146435072, 2146435072, 2146435072, 2146435072, 2146435072, 2146435072, 2146435072
    .long 3408384, 3506688, 3604992, 3703296, 5964288, 6062592, 2146435072, 2146435072, 2146435072, 2146435072, 2146435072, 2146435072, 2146435072, 2146435072, 2146435072, 2146435072, 2146435072, 2146435072, 2146435072, 2146435072, 2146435072, 2146435072, 2146435072, 2146435072, 2146435072, 2146435072, 2146435072, 2146435072, 2146435072, 2146435072, 2146435072, 2146435072
    .long 3408768, 3507072, 3605376, 3703680, 5964672, 6062976, 2146435072, 2146435072, 2146435072, 2146435072, 2146435072, 2146435072, 2146435072, 2146435072, 2146435072, 2146435072, 2146435072, 2146435072, 2146435072, 2146435072, 2146435072, 2146435072, 2146435072, 2146435072, 2146435072, 2146435072, 2146435072, 2146435072, 2146435072, 2146435072, 2146435072, 2146435072
    .long 3409152, 3507456, 3605760, 3704064, 5965056, 6063360, 2146435072, 2146435072, 2146435072, 2146435072, 2146435072, 2146435072, 2146435072, 2146435072, 2146435072, 2146435072, 2146435072, 2146435072, 2146435072, 2146435072, 2146435072, 2146435072, 2146435072, 2146435072, 2146435072, 2146435072, 2146435072, 2146435072, 2146435072, 2146435072, 2146435072, 2146435072
    .long 3409536, 3507840, 3606144, 3704448, 5965440, 6063744, 2146435072, 2146435072, 2146435072, 2146435072, 2146435072, 2146435072, 2146435072, 2146435072, 2146435072, 2146435072, 2146435072, 2146435072, 2146435072, 2146435072, 2146435072, 2146435072, 2146435072, 2146435072, 2146435072, 2146435072, 2146435072, 2146435072, 2146435072, 2146435072, 2146435072, 2146435072
    .long 4589568, 4687872, 4786176, 4884480, 5050368, 5148672, 2146435072, 2146435072, 2146435072, 2146435072, 2146435072, 2146435072, 2146435072, 2146435072, 2146435072, 2146435072, 2146435072, 2146435072, 2146435072, 2146435072, 2146435072, 2146435072, 2146435072, 2146435072, 2146435072, 2146435072, 2146435072, 2146435072, 2146435072, 2146435072, 2146435072, 2146435072
    .long 4589952, 4688256, 4786560, 4884864, 5050752, 5149056, 2146435072, 2146435072, 2146435072, 2146435072, 2146435072, 2146435072, 2146435072, 2146435072, 2146435072, 2146435072, 2146435072, 2146435072, 2146435072, 2146435072, 2146435072, 2146435072, 2146435072, 2146435072, 2146435072, 2146435072, 2146435072, 2146435072, 2146435072, 2146435072, 2146435072, 2146435072
    .long 4590336, 4688640, 4786944, 4885248, 5051136, 5149440, 2146435072, 2146435072, 2146435072, 2146435072, 2146435072, 2146435072, 2146435072, 2146435072, 2146435072, 2146435072, 2146435072, 2146435072, 2146435072, 2146435072, 2146435072, 2146435072, 2146435072, 2146435072, 2146435072, 2146435072, 2146435072, 2146435072, 2146435072, 2146435072, 2146435072, 2146435072
    .long 4590720, 4689024, 4787328, 4885632, 5051520, 5149824, 2146435072, 2146435072, 2146435072, 2146435072, 2146435072, 2146435072, 2146435072, 2146435072, 2146435072, 2146435072, 2146435072, 2146435072, 2146435072, 2146435072, 2146435072, 2146435072, 2146435072, 2146435072, 2146435072, 2146435072, 2146435072, 2146435072, 2146435072, 2146435072, 2146435072, 2146435072
    .long 4591104, 4689408, 4787712, 4886016, 5051904, 5150208, 2146435072, 2146435072, 2146435072, 2146435072, 2146435072, 2146435072, 2146435072, 2146435072, 2146435072, 2146435072, 2146435072, 2146435072, 2146435072, 2146435072, 2146435072, 2146435072, 2146435072, 2146435072, 2146435072, 2146435072, 2146435072, 2146435072, 2146435072, 2146435072, 2146435072, 2146435072
    .long 4591488, 4689792, 4788096, 4886400, 5052288, 5150592, 2146435072, 2146435072, 2146435072, 2146435072, 2146435072, 2146435072, 2146435072, 2146435072, 2146435072, 2146435072, 2146435072, 2146435072, 2146435072, 2146435072, 2146435072, 2146435072, 2146435072, 2146435072, 2146435072, 2146435072, 2146435072, 2146435072, 2146435072, 2146435072, 2146435072, 2146435072
    .long 4591872, 4690176, 4788480, 4886784, 5052672, 5150976, 2146435072, 2146435072, 2146435072, 2146435072, 2146435072, 2146435072, 2146435072, 2146435072, 2146435072, 2146435072, 2146435072, 2146435072, 2146435072, 2146435072, 2146435072, 2146435072, 2146435072, 2146435072, 2146435072, 2146435072, 2146435072, 2146435072, 2146435072, 2146435072, 2146435072, 2146435072
    .long 4592256, 4690560, 4788864, 4887168, 5053056, 5151360, 2146435072, 2146435072, 2146435072, 2146435072, 2146435072, 2146435072, 2146435072, 2146435072, 2146435072, 2146435072, 2146435072, 2146435072, 2146435072, 2146435072, 2146435072, 2146435072, 2146435072, 2146435072, 2146435072, 2146435072, 2146435072, 2146435072, 2146435072, 2146435072, 2146435072, 2146435072
    .long 5050368, 5148672, 5246976, 5345280, 4589568, 4687872, 2146435072, 2146435072, 2146435072, 2146435072, 2146435072, 2146435072, 2146435072, 2146435072, 2146435072, 2146435072, 2146435072, 2146435072, 2146435072, 2146435072, 2146435072, 2146435072, 2146435072, 2146435072, 2146435072, 2146435072, 2146435072, 2146435072, 2146435072, 2146435072, 2146435072, 2146435072
    .long 5050752, 5149056, 5247360, 5345664, 4589952, 4688256, 2146435072, 2146435072, 2146435072, 2146435072, 2146435072, 2146435072, 2146435072, 2146435072, 2146435072, 2146435072, 2146435072, 2146435072, 2146435072, 2146435072, 2146435072, 2146435072, 2146435072, 2146435072, 2146435072, 2146435072, 2146435072, 2146435072, 2146435072, 2146435072, 2146435072, 2146435072
    .long 5051136, 5149440, 5247744, 5346048, 4590336, 4688640, 2146435072, 2146435072, 2146435072, 2146435072, 2146435072, 2146435072, 2146435072, 2146435072, 2146435072, 2146435072, 2146435072, 2146435072, 2146435072, 2146435072, 2146435072, 2146435072, 2146435072, 2146435072, 2146435072, 2146435072, 2146435072, 2146435072, 2146435072, 2146435072, 2146435072, 2146435072
    .long 5051520, 5149824, 5248128, 5346432, 4590720, 4689024, 2146435072, 2146435072, 2146435072, 2146435072, 2146435072, 2146435072, 2146435072, 2146435072, 2146435072, 2146435072, 2146435072, 2146435072, 2146435072, 2146435072, 2146435072, 2146435072, 2146435072, 2146435072, 2146435072, 2146435072, 2146435072, 2146435072, 2146435072, 2146435072, 2146435072, 2146435072
    .long 5051904, 5150208, 5248512, 5346816, 4591104, 4689408, 2146435072, 2146435072, 2146435072, 2146435072, 2146435072, 2146435072, 2146435072, 2146435072, 2146435072, 2146435072, 2146435072, 2146435072, 2146435072, 2146435072, 2146435072, 2146435072, 2146435072, 2146435072, 2146435072, 2146435072, 2146435072, 2146435072, 2146435072, 2146435072, 2146435072, 2146435072
    .long 5052288, 5150592, 5248896, 5347200, 4591488, 4689792, 2146435072, 2146435072, 2146435072, 2146435072, 2146435072, 2146435072, 2146435072, 2146435072, 2146435072, 2146435072, 2146435072, 2146435072, 2146435072, 2146435072, 2146435072, 2146435072, 2146435072, 2146435072, 2146435072, 2146435072, 2146435072, 2146435072, 2146435072, 2146435072, 2146435072, 2146435072
    .long 5052672, 5150976, 5249280, 5347584, 4591872, 4690176, 2146435072, 2146435072, 2146435072, 2146435072, 2146435072, 2146435072, 2146435072, 2146435072, 2146435072, 2146435072, 2146435072, 2146435072, 2146435072, 2146435072, 2146435072, 2146435072, 2146435072, 2146435072, 2146435072, 2146435072, 2146435072, 2146435072, 2146435072, 2146435072, 2146435072, 2146435072
    .long 5053056, 5151360, 5249664, 5347968, 4592256, 4690560, 2146435072, 2146435072, 2146435072, 2146435072, 2146435072, 2146435072, 2146435072, 2146435072, 2146435072, 2146435072, 2146435072, 2146435072, 2146435072, 2146435072, 2146435072, 2146435072, 2146435072, 2146435072, 2146435072, 2146435072, 2146435072, 2146435072, 2146435072, 2146435072, 2146435072, 2146435072
    .long 5962752, 6061056, 6159360, 6257664, 4349952, 4448256, 2146435072, 2146435072, 2146435072, 2146435072, 2146435072, 2146435072, 2146435072, 2146435072, 2146435072, 2146435072, 2146435072, 2146435072, 2146435072, 2146435072, 2146435072, 2146435072, 2146435072, 2146435072, 2146435072, 2146435072, 2146435072, 2146435072, 2146435072, 2146435072, 2146435072, 2146435072
    .long 5963136, 6061440, 6159744, 6258048, 4350336, 4448640, 2146435072, 2146435072, 2146435072, 2146435072, 2146435072, 2146435072, 2146435072, 2146435072, 2146435072, 2146435072, 2146435072, 2146435072, 2146435072, 2146435072, 2146435072, 2146435072, 2146435072, 2146435072, 2146435072, 2146435072, 2146435072, 2146435072, 2146435072, 2146435072, 2146435072, 2146435072
    .long 5963520, 6061824, 6160128, 6258432, 4350720, 4449024, 2146435072, 2146435072, 2146435072, 2146435072, 2146435072, 2146435072, 2146435072, 2146435072, 2146435072, 2146435072, 2146435072, 2146435072, 2146435072, 2146435072, 2146435072, 2146435072, 2146435072, 2146435072, 2146435072, 2146435072, 2146435072, 2146435072, 2146435072, 2146435072, 2146435072, 2146435072
    .long 5963904, 6062208, 6160512, 6258816, 4351104, 4449408, 2146435072, 2146435072, 2146435072, 2146435072, 2146435072, 2146435072, 2146435072, 2146435072, 2146435072, 2146435072, 2146435072, 2146435072, 2146435072, 2146435072, 2146435072, 2146435072, 2146435072, 2146435072, 2146435072, 2146435072, 2146435072, 2146435072, 2146435072, 2146435072, 2146435072, 2146435072
    .long 5964288, 6062592, 6160896, 6259200, 4351488, 4449792, 2146435072, 2146435072, 2146435072, 2146435072, 2146435072, 2146435072, 2146435072, 2146435072, 2146435072, 2146435072, 2146435072, 2146435072, 2146435072, 2146435072, 2146435072, 2146435072, 2146435072, 2146435072, 2146435072, 2146435072, 2146435072, 2146435072, 2146435072, 2146435072, 2146435072, 2146435072
    .long 5964672, 6062976, 6161280, 6259584, 4351872, 4450176, 2146435072, 2146435072, 2146435072, 2146435072, 2146435072, 2146435072, 2146435072, 2146435072, 2146435072, 2146435072, 2146435072, 2146435072, 2146435072, 2146435072, 2146435072, 2146435072, 2146435072, 2146435072, 2146435072, 2146435072, 2146435072, 2146435072, 2146435072, 2146435072, 2146435072, 2146435072
    .long 5965056, 6063360, 6161664, 6259968, 4352256, 4450560, 2146435072, 2146435072, 2146435072, 2146435072, 2146435072, 2146435072, 2146435072, 2146435072, 2146435072, 2146435072, 2146435072, 2146435072, 2146435072, 2146435072, 2146435072, 2146435072, 2146435072, 2146435072, 2146435072, 2146435072, 2146435072, 2146435072, 2146435072, 2146435072, 2146435072, 2146435072
    .long 5965440, 6063744, 6162048, 6260352, 4352640, 4450944, 2146435072, 2146435072, 2146435072, 2146435072, 2146435072, 2146435072, 2146435072, 2146435072, 2146435072, 2146435072, 2146435072, 2146435072, 2146435072, 2146435072, 2146435072, 2146435072, 2146435072, 2146435072, 2146435072, 2146435072, 2146435072, 2146435072, 2146435072, 2146435072, 2146435072, 2146435072
    .long 0, 98304, 589824, 491520, 393216, 294912, 196608, 688128, 2146435072, 2146435072, 2146435072, 2146435072, 2146435072, 2146435072, 2146435072, 2146435072, 2146435072, 2146435072, 2146435072, 2146435072, 2146435072, 2146435072, 2146435072, 2146435072, 2146435072, 2146435072, 2146435072, 2146435072, 2146435072, 2146435072, 2146435072, 2146435072
    .long 384, 98688, 590208, 491904, 393600, 295296, 196992, 688512, 2146435072, 2146435072, 2146435072, 2146435072, 2146435072, 2146435072, 2146435072, 2146435072, 2146435072, 2146435072, 2146435072, 2146435072, 2146435072, 2146435072, 2146435072, 2146435072, 2146435072, 2146435072, 2146435072, 2146435072, 2146435072, 2146435072, 2146435072, 2146435072
    .long 768, 99072, 590592, 492288, 393984, 295680, 197376, 688896, 2146435072, 2146435072, 2146435072, 2146435072, 2146435072, 2146435072, 2146435072, 2146435072, 2146435072, 2146435072, 2146435072, 2146435072, 2146435072, 2146435072, 2146435072, 2146435072, 2146435072, 2146435072, 2146435072, 2146435072, 2146435072, 2146435072, 2146435072, 2146435072
    .long 1152, 99456, 590976, 492672, 394368, 296064, 197760, 689280, 2146435072, 2146435072, 2146435072, 2146435072, 2146435072, 2146435072, 2146435072, 2146435072, 2146435072, 2146435072, 2146435072, 2146435072, 2146435072, 2146435072, 2146435072, 2146435072, 2146435072, 2146435072, 2146435072, 2146435072, 2146435072, 2146435072, 2146435072, 2146435072
    .long 1536, 99840, 591360, 493056, 394752, 296448, 198144, 689664, 2146435072, 2146435072, 2146435072, 2146435072, 2146435072, 2146435072, 2146435072, 2146435072, 2146435072, 2146435072, 2146435072, 2146435072, 2146435072, 2146435072, 2146435072, 2146435072, 2146435072, 2146435072, 2146435072, 2146435072, 2146435072, 2146435072, 2146435072, 2146435072
    .long 1920, 100224, 591744, 493440, 395136, 296832, 198528, 690048, 2146435072, 2146435072, 2146435072, 2146435072, 2146435072, 2146435072, 2146435072, 2146435072, 2146435072, 2146435072, 2146435072, 2146435072, 2146435072, 2146435072, 2146435072, 2146435072, 2146435072, 2146435072, 2146435072, 2146435072, 2146435072, 2146435072, 2146435072, 2146435072
    .long 2304, 100608, 592128, 493824, 395520, 297216, 198912, 690432, 2146435072, 2146435072, 2146435072, 2146435072, 2146435072, 2146435072, 2146435072, 2146435072, 2146435072, 2146435072, 2146435072, 2146435072, 2146435072, 2146435072, 2146435072, 2146435072, 2146435072, 2146435072, 2146435072, 2146435072, 2146435072, 2146435072, 2146435072, 2146435072
    .long 2688, 100992, 592512, 494208, 395904, 297600, 199296, 690816, 2146435072, 2146435072, 2146435072, 2146435072, 2146435072, 2146435072, 2146435072, 2146435072, 2146435072, 2146435072, 2146435072, 2146435072, 2146435072, 2146435072, 2146435072, 2146435072, 2146435072, 2146435072, 2146435072, 2146435072, 2146435072, 2146435072, 2146435072, 2146435072
    .long 1990656, 2088960, 2580480, 2482176, 2383872, 2285568, 2187264, 2678784, 2146435072, 2146435072, 2146435072, 2146435072, 2146435072, 2146435072, 2146435072, 2146435072, 2146435072, 2146435072, 2146435072, 2146435072, 2146435072, 2146435072, 2146435072, 2146435072, 2146435072, 2146435072, 2146435072, 2146435072, 2146435072, 2146435072, 2146435072, 2146435072
    .long 1991040, 2089344, 2580864, 2482560, 2384256, 2285952, 2187648, 2679168, 2146435072, 2146435072, 2146435072, 2146435072, 2146435072, 2146435072, 2146435072, 2146435072, 2146435072, 2146435072, 2146435072, 2146435072, 2146435072, 2146435072, 2146435072, 2146435072, 2146435072, 2146435072, 2146435072, 2146435072, 2146435072, 2146435072, 2146435072, 2146435072
    .long 1991424, 2089728, 2581248, 2482944, 2384640, 2286336, 2188032, 2679552, 2146435072, 2146435072, 2146435072, 2146435072, 2146435072, 2146435072, 2146435072, 2146435072, 2146435072, 2146435072, 2146435072, 2146435072, 2146435072, 2146435072, 2146435072, 2146435072, 2146435072, 2146435072, 2146435072, 2146435072, 2146435072, 2146435072, 2146435072, 2146435072
    .long 1991808, 2090112, 2581632, 2483328, 2385024, 2286720, 2188416, 2679936, 2146435072, 2146435072, 2146435072, 2146435072, 2146435072, 2146435072, 2146435072, 2146435072, 2146435072, 2146435072, 2146435072, 2146435072, 2146435072, 2146435072, 2146435072, 2146435072, 2146435072, 2146435072, 2146435072, 2146435072, 2146435072, 2146435072, 2146435072, 2146435072
    .long 1992192, 2090496, 2582016, 2483712, 2385408, 2287104, 2188800, 2680320, 2146435072, 2146435072, 2146435072, 2146435072, 2146435072, 2146435072, 2146435072, 2146435072, 2146435072, 2146435072, 2146435072, 2146435072, 2146435072, 2146435072, 2146435072, 2146435072, 2146435072, 2146435072, 2146435072, 2146435072, 2146435072, 2146435072, 2146435072, 2146435072
    .long 1992576, 2090880, 2582400, 2484096, 2385792, 2287488, 2189184, 2680704, 2146435072, 2146435072, 2146435072, 2146435072, 2146435072, 2146435072, 2146435072, 2146435072, 2146435072, 2146435072, 2146435072, 2146435072, 2146435072, 2146435072, 2146435072, 2146435072, 2146435072, 2146435072, 2146435072, 2146435072, 2146435072, 2146435072, 2146435072, 2146435072
    .long 1992960, 2091264, 2582784, 2484480, 2386176, 2287872, 2189568, 2681088, 2146435072, 2146435072, 2146435072, 2146435072, 2146435072, 2146435072, 2146435072, 2146435072, 2146435072, 2146435072, 2146435072, 2146435072, 2146435072, 2146435072, 2146435072, 2146435072, 2146435072, 2146435072, 2146435072, 2146435072, 2146435072, 2146435072, 2146435072, 2146435072
    .long 1993344, 2091648, 2583168, 2484864, 2386560, 2288256, 2189952, 2681472, 2146435072, 2146435072, 2146435072, 2146435072, 2146435072, 2146435072, 2146435072, 2146435072, 2146435072, 2146435072, 2146435072, 2146435072, 2146435072, 2146435072, 2146435072, 2146435072, 2146435072, 2146435072, 2146435072, 2146435072, 2146435072, 2146435072, 2146435072, 2146435072
    .long 3406848, 3505152, 3996672, 3898368, 3800064, 3701760, 3603456, 4094976, 2146435072, 2146435072, 2146435072, 2146435072, 2146435072, 2146435072, 2146435072, 2146435072, 2146435072, 2146435072, 2146435072, 2146435072, 2146435072, 2146435072, 2146435072, 2146435072, 2146435072, 2146435072, 2146435072, 2146435072, 2146435072, 2146435072, 2146435072, 2146435072
    .long 3407232, 3505536, 3997056, 3898752, 3800448, 3702144, 3603840, 4095360, 2146435072, 2146435072, 2146435072, 2146435072, 2146435072, 2146435072, 2146435072, 2146435072, 2146435072, 2146435072, 2146435072, 2146435072, 2146435072, 2146435072, 2146435072, 2146435072, 2146435072, 2146435072, 2146435072, 2146435072, 2146435072, 2146435072, 2146435072, 2146435072
    .long 3407616, 3505920, 3997440, 3899136, 3800832, 3702528, 3604224, 4095744, 2146435072, 2146435072, 2146435072, 2146435072, 2146435072, 2146435072, 2146435072, 2146435072, 2146435072, 2146435072, 2146435072, 2146435072, 2146435072, 2146435072, 2146435072, 2146435072, 2146435072, 2146435072, 2146435072, 2146435072, 2146435072, 2146435072, 2146435072, 2146435072
    .long 3408000, 3506304, 3997824, 3899520, 3801216, 3702912, 3604608, 4096128, 2146435072, 2146435072, 2146435072, 2146435072, 2146435072, 2146435072, 2146435072, 2146435072, 2146435072, 2146435072, 2146435072, 2146435072, 2146435072, 2146435072, 2146435072, 2146435072, 2146435072, 2146435072, 2146435072, 2146435072, 2146435072, 2146435072, 2146435072, 2146435072
    .long 3408384, 3506688, 3998208, 3899904, 3801600, 3703296, 3604992, 4096512, 2146435072, 2146435072, 2146435072, 2146435072, 2146435072, 2146435072, 2146435072, 2146435072, 2146435072, 2146435072, 2146435072, 2146435072, 2146435072, 2146435072, 2146435072, 2146435072, 2146435072, 2146435072, 2146435072, 2146435072, 2146435072, 2146435072, 2146435072, 2146435072
    .long 3408768, 3507072, 3998592, 3900288, 3801984, 3703680, 3605376, 4096896, 2146435072, 2146435072, 2146435072, 2146435072, 2146435072, 2146435072, 2146435072, 2146435072, 2146435072, 2146435072, 2146435072, 2146435072, 2146435072, 2146435072, 2146435072, 2146435072, 2146435072, 2146435072, 2146435072, 2146435072, 2146435072, 2146435072, 2146435072, 2146435072
    .long 3409152, 3507456, 3998976, 3900672, 3802368, 3704064, 3605760, 4097280, 2146435072, 2146435072, 2146435072, 2146435072, 2146435072, 2146435072, 2146435072, 2146435072, 2146435072, 2146435072, 2146435072, 2146435072, 2146435072, 2146435072, 2146435072, 2146435072, 2146435072, 2146435072, 2146435072, 2146435072, 2146435072, 2146435072, 2146435072, 2146435072
    .long 3409536, 3507840, 3999360, 3901056, 3802752, 3704448, 3606144, 4097664, 2146435072, 2146435072, 2146435072, 2146435072, 2146435072, 2146435072, 2146435072, 2146435072, 2146435072, 2146435072, 2146435072, 2146435072, 2146435072, 2146435072, 2146435072, 2146435072, 2146435072, 2146435072, 2146435072, 2146435072, 2146435072, 2146435072, 2146435072, 2146435072
    .long 5050368, 5148672, 5640192, 5541888, 5443584, 5345280, 5246976, 5738496, 2146435072, 2146435072, 2146435072, 2146435072, 2146435072, 2146435072, 2146435072, 2146435072, 2146435072, 2146435072, 2146435072, 2146435072, 2146435072, 2146435072, 2146435072, 2146435072, 2146435072, 2146435072, 2146435072, 2146435072, 2146435072, 2146435072, 2146435072, 2146435072
    .long 5050752, 5149056, 5640576, 5542272, 5443968, 5345664, 5247360, 5738880, 2146435072, 2146435072, 2146435072, 2146435072, 2146435072, 2146435072, 2146435072, 2146435072, 2146435072, 2146435072, 2146435072, 2146435072, 2146435072, 2146435072, 2146435072, 2146435072, 2146435072, 2146435072, 2146435072, 2146435072, 2146435072, 2146435072, 2146435072, 2146435072
    .long 5051136, 5149440, 5640960, 5542656, 5444352, 5346048, 5247744, 5739264, 2146435072, 2146435072, 2146435072, 2146435072, 2146435072, 2146435072, 2146435072, 2146435072, 2146435072, 2146435072, 2146435072, 2146435072, 2146435072, 2146435072, 2146435072, 2146435072, 2146435072, 2146435072, 2146435072, 2146435072, 2146435072, 2146435072, 2146435072, 2146435072
    .long 5051520, 5149824, 5641344, 5543040, 5444736, 5346432, 5248128, 5739648, 2146435072, 2146435072, 2146435072, 2146435072, 2146435072, 2146435072, 2146435072, 2146435072, 2146435072, 2146435072, 2146435072, 2146435072, 2146435072, 2146435072, 2146435072, 2146435072, 2146435072, 2146435072, 2146435072, 2146435072, 2146435072, 2146435072, 2146435072, 2146435072
    .long 5051904, 5150208, 5641728, 5543424, 5445120, 5346816, 5248512, 5740032, 2146435072, 2146435072, 2146435072, 2146435072, 2146435072, 2146435072, 2146435072, 2146435072, 2146435072, 2146435072, 2146435072, 2146435072, 2146435072, 2146435072, 2146435072, 2146435072, 2146435072, 2146435072, 2146435072, 2146435072, 2146435072, 2146435072, 2146435072, 2146435072
    .long 5052288, 5150592, 5642112, 5543808, 5445504, 5347200, 5248896, 5740416, 2146435072, 2146435072, 2146435072, 2146435072, 2146435072, 2146435072, 2146435072, 2146435072, 2146435072, 2146435072, 2146435072, 2146435072, 2146435072, 2146435072, 2146435072, 2146435072, 2146435072, 2146435072, 2146435072, 2146435072, 2146435072, 2146435072, 2146435072, 2146435072
    .long 5052672, 5150976, 5642496, 5544192, 5445888, 5347584, 5249280, 5740800, 2146435072, 2146435072, 2146435072, 2146435072, 2146435072, 2146435072, 2146435072, 2146435072, 2146435072, 2146435072, 2146435072, 2146435072, 2146435072, 2146435072, 2146435072, 2146435072, 2146435072, 2146435072, 2146435072, 2146435072, 2146435072, 2146435072, 2146435072, 2146435072
    .long 5053056, 5151360, 5642880, 5544576, 5446272, 5347968, 5249664, 5741184, 2146435072, 2146435072, 2146435072, 2146435072, 2146435072, 2146435072, 2146435072, 2146435072, 2146435072, 2146435072, 2146435072, 2146435072, 2146435072, 2146435072, 2146435072, 2146435072, 2146435072, 2146435072, 2146435072, 2146435072, 2146435072, 2146435072, 2146435072, 2146435072
    .long 5962752, 6061056, 6552576, 6454272, 6355968, 6257664, 6159360, 6650880, 2146435072, 2146435072, 2146435072, 2146435072, 2146435072, 2146435072, 2146435072, 2146435072, 2146435072, 2146435072, 2146435072, 2146435072, 2146435072, 2146435072, 2146435072, 2146435072, 2146435072, 2146435072, 2146435072, 2146435072, 2146435072, 2146435072, 2146435072, 2146435072
    .long 5963136, 6061440, 6552960, 6454656, 6356352, 6258048, 6159744, 6651264, 2146435072, 2146435072, 2146435072, 2146435072, 2146435072, 2146435072, 2146435072, 2146435072, 2146435072, 2146435072, 2146435072, 2146435072, 2146435072, 2146435072, 2146435072, 2146435072, 2146435072, 2146435072, 2146435072, 2146435072, 2146435072, 2146435072, 2146435072, 2146435072
    .long 5963520, 6061824, 6553344, 6455040, 6356736, 6258432, 6160128, 6651648, 2146435072, 2146435072, 2146435072, 2146435072, 2146435072, 2146435072, 2146435072, 2146435072, 2146435072, 2146435072, 2146435072, 2146435072, 2146435072, 2146435072, 2146435072, 2146435072, 2146435072, 2146435072, 2146435072, 2146435072, 2146435072, 2146435072, 2146435072, 2146435072
    .long 5963904, 6062208, 6553728, 6455424, 6357120, 6258816, 6160512, 6652032, 2146435072, 2146435072, 2146435072, 2146435072, 2146435072, 2146435072, 2146435072, 2146435072, 2146435072, 2146435072, 2146435072, 2146435072, 2146435072, 2146435072, 2146435072, 2146435072, 2146435072, 2146435072, 2146435072, 2146435072, 2146435072, 2146435072, 2146435072, 2146435072
    .long 5964288, 6062592, 6554112, 6455808, 6357504, 6259200, 6160896, 6652416, 2146435072, 2146435072, 2146435072, 2146435072, 2146435072, 2146435072, 2146435072, 2146435072, 2146435072, 2146435072, 2146435072, 2146435072, 2146435072, 2146435072, 2146435072, 2146435072, 2146435072, 2146435072, 2146435072, 2146435072, 2146435072, 2146435072, 2146435072, 2146435072
    .long 5964672, 6062976, 6554496, 6456192, 6357888, 6259584, 6161280, 6652800, 2146435072, 2146435072, 2146435072, 2146435072, 2146435072, 2146435072, 2146435072, 2146435072, 2146435072, 2146435072, 2146435072, 2146435072, 2146435072, 2146435072, 2146435072, 2146435072, 2146435072, 2146435072, 2146435072, 2146435072, 2146435072, 2146435072, 2146435072, 2146435072
    .long 5965056, 6063360, 6554880, 6456576, 6358272, 6259968, 6161664, 6653184, 2146435072, 2146435072, 2146435072, 2146435072, 2146435072, 2146435072, 2146435072, 2146435072, 2146435072, 2146435072, 2146435072, 2146435072, 2146435072, 2146435072, 2146435072, 2146435072, 2146435072, 2146435072, 2146435072, 2146435072, 2146435072, 2146435072, 2146435072, 2146435072
    .long 5965440, 6063744, 6555264, 6456960, 6358656, 6260352, 6162048, 6653568, 2146435072, 2146435072, 2146435072, 2146435072, 2146435072, 2146435072, 2146435072, 2146435072, 2146435072, 2146435072, 2146435072, 2146435072, 2146435072, 2146435072, 2146435072, 2146435072, 2146435072, 2146435072, 2146435072, 2146435072, 2146435072, 2146435072, 2146435072, 2146435072
    .long 3406848, 3505152, 3800064, 3701760, 3603456, 3898368, 2146435072, 2146435072, 2146435072, 2146435072, 2146435072, 2146435072, 2146435072, 2146435072, 2146435072, 2146435072, 2146435072, 2146435072, 2146435072, 2146435072, 2146435072, 2146435072, 2146435072, 2146435072, 2146435072, 2146435072, 2146435072, 2146435072, 2146435072, 2146435072, 2146435072, 2146435072
    .long 3407232, 3505536, 3800448, 3702144, 3603840, 3898752, 2146435072, 2146435072, 2146435072, 2146435072, 2146435072, 2146435072, 2146435072, 2146435072, 2146435072, 2146435072, 2146435072, 2146435072, 2146435072, 2146435072, 2146435072, 2146435072, 2146435072, 2146435072, 2146435072, 2146435072, 2146435072, 2146435072, 2146435072, 2146435072, 2146435072, 2146435072
    .long 3407616, 3505920, 3800832, 3702528, 3604224, 3899136, 2146435072, 2146435072, 2146435072, 2146435072, 2146435072, 2146435072, 2146435072, 2146435072, 2146435072, 2146435072, 2146435072, 2146435072, 2146435072, 2146435072, 2146435072, 2146435072, 2146435072, 2146435072, 2146435072, 2146435072, 2146435072, 2146435072, 2146435072, 2146435072, 2146435072, 2146435072
    .long 3408000, 3506304, 3801216, 3702912, 3604608, 3899520, 2146435072, 2146435072, 2146435072, 2146435072, 2146435072, 2146435072, 2146435072, 2146435072, 2146435072, 2146435072, 2146435072, 2146435072, 2146435072, 2146435072, 2146435072, 2146435072, 2146435072, 2146435072, 2146435072, 2146435072, 2146435072, 2146435072, 2146435072, 2146435072, 2146435072, 2146435072
    .long 3408384, 3506688, 3801600, 3703296, 3604992, 3899904, 2146435072, 2146435072, 2146435072, 2146435072, 2146435072, 2146435072, 2146435072, 2146435072, 2146435072, 2146435072, 2146435072, 2146435072, 2146435072, 2146435072, 2146435072, 2146435072, 2146435072, 2146435072, 2146435072, 2146435072, 2146435072, 2146435072, 2146435072, 2146435072, 2146435072, 2146435072
    .long 3408768, 3507072, 3801984, 3703680, 3605376, 3900288, 2146435072, 2146435072, 2146435072, 2146435072, 2146435072, 2146435072, 2146435072, 2146435072, 2146435072, 2146435072, 2146435072, 2146435072, 2146435072, 2146435072, 2146435072, 2146435072, 2146435072, 2146435072, 2146435072, 2146435072, 2146435072, 2146435072, 2146435072, 2146435072, 2146435072, 2146435072
    .long 3409152, 3507456, 3802368, 3704064, 3605760, 3900672, 2146435072, 2146435072, 2146435072, 2146435072, 2146435072, 2146435072, 2146435072, 2146435072, 2146435072, 2146435072, 2146435072, 2146435072, 2146435072, 2146435072, 2146435072, 2146435072, 2146435072, 2146435072, 2146435072, 2146435072, 2146435072, 2146435072, 2146435072, 2146435072, 2146435072, 2146435072
    .long 3409536, 3507840, 3802752, 3704448, 3606144, 3901056, 2146435072, 2146435072, 2146435072, 2146435072, 2146435072, 2146435072, 2146435072, 2146435072, 2146435072, 2146435072, 2146435072, 2146435072, 2146435072, 2146435072, 2146435072, 2146435072, 2146435072, 2146435072, 2146435072, 2146435072, 2146435072, 2146435072, 2146435072, 2146435072, 2146435072, 2146435072
    .long 5050368, 5148672, 5443584, 5345280, 5246976, 5541888, 2146435072, 2146435072, 2146435072, 2146435072, 2146435072, 2146435072, 2146435072, 2146435072, 2146435072, 2146435072, 2146435072, 2146435072, 2146435072, 2146435072, 2146435072, 2146435072, 2146435072, 2146435072, 2146435072, 2146435072, 2146435072, 2146435072, 2146435072, 2146435072, 2146435072, 2146435072
    .long 5050752, 5149056, 5443968, 5345664, 5247360, 5542272, 2146435072, 2146435072, 2146435072, 2146435072, 2146435072, 2146435072, 2146435072, 2146435072, 2146435072, 2146435072, 2146435072, 2146435072, 2146435072, 2146435072, 2146435072, 2146435072, 2146435072, 2146435072, 2146435072, 2146435072, 2146435072, 2146435072, 2146435072, 2146435072, 2146435072, 2146435072
    .long 5051136, 5149440, 5444352, 5346048, 5247744, 5542656, 2146435072, 2146435072, 2146435072, 2146435072, 2146435072, 2146435072, 2146435072, 2146435072, 2146435072, 2146435072, 2146435072, 2146435072, 2146435072, 2146435072, 2146435072, 2146435072, 2146435072, 2146435072, 2146435072, 2146435072, 2146435072, 2146435072, 2146435072, 2146435072, 2146435072, 2146435072
    .long 5051520, 5149824, 5444736, 5346432, 5248128, 5543040, 2146435072, 2146435072, 2146435072, 2146435072, 2146435072, 2146435072, 2146435072, 2146435072, 2146435072, 2146435072, 2146435072, 2146435072, 2146435072, 2146435072, 2146435072, 2146435072, 2146435072, 2146435072, 2146435072, 2146435072, 2146435072, 2146435072, 2146435072, 2146435072, 2146435072, 2146435072
    .long 5051904, 5150208, 5445120, 5346816, 5248512, 5543424, 2146435072, 2146435072, 2146435072, 2146435072, 2146435072, 2146435072, 2146435072, 2146435072, 2146435072, 2146435072, 2146435072, 2146435072, 2146435072, 2146435072, 2146435072, 2146435072, 2146435072, 2146435072, 2146435072, 2146435072, 2146435072, 2146435072, 2146435072, 2146435072, 2146435072, 2146435072
    .long 5052288, 5150592, 5445504, 5347200, 5248896, 5543808, 2146435072, 2146435072, 2146435072, 2146435072, 2146435072, 2146435072, 2146435072, 2146435072, 2146435072, 2146435072, 2146435072, 2146435072, 2146435072, 2146435072, 2146435072, 2146435072, 2146435072, 2146435072, 2146435072, 2146435072, 2146435072, 2146435072, 2146435072, 2146435072, 2146435072, 2146435072
    .long 5052672, 5150976, 5445888, 5347584, 5249280, 5544192, 2146435072, 2146435072, 2146435072, 2146435072, 2146435072, 2146435072, 2146435072, 2146435072, 2146435072, 2146435072, 2146435072, 2146435072, 2146435072, 2146435072, 2146435072, 2146435072, 2146435072, 2146435072, 2146435072, 2146435072, 2146435072, 2146435072, 2146435072, 2146435072, 2146435072, 2146435072
    .long 5053056, 5151360, 5446272, 5347968, 5249664, 5544576, 2146435072, 2146435072, 2146435072, 2146435072, 2146435072, 2146435072, 2146435072, 2146435072, 2146435072, 2146435072, 2146435072, 2146435072, 2146435072, 2146435072, 2146435072, 2146435072, 2146435072, 2146435072, 2146435072, 2146435072, 2146435072, 2146435072, 2146435072, 2146435072, 2146435072, 2146435072
    .long 5962752, 6061056, 6355968, 6257664, 6159360, 6454272, 2146435072, 2146435072, 2146435072, 2146435072, 2146435072, 2146435072, 2146435072, 2146435072, 2146435072, 2146435072, 2146435072, 2146435072, 2146435072, 2146435072, 2146435072, 2146435072, 2146435072, 2146435072, 2146435072, 2146435072, 2146435072, 2146435072, 2146435072, 2146435072, 2146435072, 2146435072
    .long 5963136, 6061440, 6356352, 6258048, 6159744, 6454656, 2146435072, 2146435072, 2146435072, 2146435072, 2146435072, 2146435072, 2146435072, 2146435072, 2146435072, 2146435072, 2146435072, 2146435072, 2146435072, 2146435072, 2146435072, 2146435072, 2146435072, 2146435072, 2146435072, 2146435072, 2146435072, 2146435072, 2146435072, 2146435072, 2146435072, 2146435072
    .long 5963520, 6061824, 6356736, 6258432, 6160128, 6455040, 2146435072, 2146435072, 2146435072, 2146435072, 2146435072, 2146435072, 2146435072, 2146435072, 2146435072, 2146435072, 2146435072, 2146435072, 2146435072, 2146435072, 2146435072, 2146435072, 2146435072, 2146435072, 2146435072, 2146435072, 2146435072, 2146435072, 2146435072, 2146435072, 2146435072, 2146435072
    .long 5963904, 6062208, 6357120, 6258816, 6160512, 6455424, 2146435072, 2146435072, 2146435072, 2146435072, 2146435072, 2146435072, 2146435072, 2146435072, 2146435072, 2146435072, 2146435072, 2146435072, 2146435072, 2146435072, 2146435072, 2146435072, 2146435072, 2146435072, 2146435072, 2146435072, 2146435072, 2146435072, 2146435072, 2146435072, 2146435072, 2146435072
    .long 5964288, 6062592, 6357504, 6259200, 6160896, 6455808, 2146435072, 2146435072, 2146435072, 2146435072, 2146435072, 2146435072, 2146435072, 2146435072, 2146435072, 2146435072, 2146435072, 2146435072, 2146435072, 2146435072, 2146435072, 2146435072, 2146435072, 2146435072, 2146435072, 2146435072, 2146435072, 2146435072, 2146435072, 2146435072, 2146435072, 2146435072
    .long 5964672, 6062976, 6357888, 6259584, 6161280, 6456192, 2146435072, 2146435072, 2146435072, 2146435072, 2146435072, 2146435072, 2146435072, 2146435072, 2146435072, 2146435072, 2146435072, 2146435072, 2146435072, 2146435072, 2146435072, 2146435072, 2146435072, 2146435072, 2146435072, 2146435072, 2146435072, 2146435072, 2146435072, 2146435072, 2146435072, 2146435072
    .long 5965056, 6063360, 6358272, 6259968, 6161664, 6456576, 2146435072, 2146435072, 2146435072, 2146435072, 2146435072, 2146435072, 2146435072, 2146435072, 2146435072, 2146435072, 2146435072, 2146435072, 2146435072, 2146435072, 2146435072, 2146435072, 2146435072, 2146435072, 2146435072, 2146435072, 2146435072, 2146435072, 2146435072, 2146435072, 2146435072, 2146435072
    .long 5965440, 6063744, 6358656, 6260352, 6162048, 6456960, 2146435072, 2146435072, 2146435072, 2146435072, 2146435072, 2146435072, 2146435072, 2146435072, 2146435072, 2146435072, 2146435072, 2146435072, 2146435072, 2146435072, 2146435072, 2146435072, 2146435072, 2146435072, 2146435072, 2146435072, 2146435072, 2146435072, 2146435072, 2146435072, 2146435072, 2146435072
.section .rodata,"a"
.p2align 6
.amdhsa_kernel standalone__ragged_sequences_varlen_flash_attn__ragged_kernel
  .amdhsa_next_free_vgpr 448
  .amdhsa_next_free_sgpr 102
  .amdhsa_accum_offset 256
  .amdhsa_group_segment_fixed_size 0
  .amdhsa_kernarg_size 56
  .amdhsa_user_sgpr_count 2
  .amdhsa_user_sgpr_kernarg_segment_ptr 1
  .amdhsa_system_sgpr_workgroup_id_x 1
.end_amdhsa_kernel
```
